```python
import torch

def _softmax(x, axis=-1):
    return torch.softmax(x, dim=axis)
def _gelu(x):
    return torch.nn.functional.gelu(x, approximate="tanh")
def _silu(x):
    return torch.nn.functional.silu(x)
def _sigmoid(x):
    return torch.sigmoid(x)
def _layernorm(x, axis=-1, eps=1e-5):
    m = x.mean(dim=axis, keepdim=True)
    v = x.var(dim=axis, keepdim=True, unbiased=False)
    return (x - m) / torch.sqrt(v + eps)
def _scatter_add(tgt, idx, src, axis=0):
    return tgt.clone().index_add_(axis, idx, src)
def _segment_sum(src, seg, n):
    out = torch.zeros((n,) + src.shape[1:], dtype=src.dtype)
    return out.index_add_(0, seg, src)
def _pad(x, pw):
    flat = tuple(v for pair in reversed(pw) for v in pair)
    return torch.nn.functional.pad(x, flat)

kernel_name = 'recurrent_scan__linear_kernel_hedgehog__geglu_ffn__prompt'

def setup_inputs():

    _w = (lambda a: (lambda t: t.to(torch.bfloat16) if t.is_floating_point() else t)(torch.as_tensor(a)))
    def _A_setup():
        B, S, D, H = 1, 2048, 512, 32
        Dh = D // H
        return {
            "x": _w((lambda *s: torch.randn(*s, dtype=torch.bfloat16) * 0.05)(B, S, D)),
            "wqkv": _w((lambda *s: torch.randn(*s, dtype=torch.bfloat16) * 0.2)(D, 3 * D)),
            "w_phi": _w((lambda *s: torch.randn(*s, dtype=torch.bfloat16) * 0.2)(H, Dh, Dh) * (Dh ** -0.5)),
            "wo": _w((lambda *s: torch.randn(*s, dtype=torch.bfloat16) * 0.05)(D, D)),
        }
    _A_in = _A_setup()

    def _B_setup():
        B, S, D, F = 1, 2048, 512, 1376
        return {
            "x": _w((lambda *s: torch.randn(*s, dtype=torch.bfloat16) * 0.05)(B, S, D)),
            "w_gate": _w((lambda *s: torch.randn(*s, dtype=torch.bfloat16) * 0.05)(D, F)),
            "w_up": _w((lambda *s: torch.randn(*s, dtype=torch.bfloat16) * 0.05)(D, F)),
            "w_down": _w((lambda *s: torch.randn(*s, dtype=torch.bfloat16) * 0.05)(F, D)),
        }
    _B_in = _B_setup()

    return {
        "A_x": _A_in["x"],
        "A_wqkv": _A_in["wqkv"],
        "A_w_phi": _A_in["w_phi"],
        "A_wo": _A_in["wo"],
        "B_x": _B_in["x"],
        "B_w_gate": _B_in["w_gate"],
        "B_w_up": _B_in["w_up"],
        "B_w_down": _B_in["w_down"],
    }

def reference(A_x, A_wqkv, A_w_phi, A_wo, B_x, B_w_gate, B_w_up, B_w_down):
    def _A_ref(x, wqkv, w_phi, wo):
        B, S, D = x.shape
        H = 32; Dh = D // H
        qkv = (lambda x, *d: x.permute(*d))((x @ wqkv).reshape(B, S, 3, H, Dh), 2, 0, 3, 1, 4)
        q, k, v = qkv[0], qkv[1], qkv[2]
        pq = torch.einsum("bhsd,hdf->bhsf", q, w_phi)
        pk = torch.einsum("bhsd,hdf->bhsf", k, w_phi)
        phi_q = torch.concatenate([_softmax(pq, axis=-1), _softmax(-pq, axis=-1)], axis=-1)
        phi_k = torch.concatenate([_softmax(pk, axis=-1), _softmax(-pk, axis=-1)], axis=-1)
        kv = torch.einsum("bhsf,bhsd->bhfd", phi_k, v)
        z  = torch.einsum("bhsf->bhf", phi_k)
        num = torch.einsum("bhqf,bhfd->bhqd", phi_q, kv)
        den = torch.einsum("bhqf,bhf->bhq", phi_q, z)[..., None] + 1e-6
        o = num / den
        return (lambda x, *d: x.permute(*d))(o, 0, 2, 1, 3).reshape(B, S, D) @ wo

    def _B_ref(x, w_gate, w_up, w_down):
        return (_gelu(x @ w_gate) * (x @ w_up)) @ w_down

    x = A_x
    xn = _layernorm(x, axis=-1)
    s = _A_ref(xn, A_wqkv, A_w_phi, A_wo)
    g = _silu(_B_ref(xn, B_w_gate, B_w_up, B_w_down))
    return x + s * g
```

```asm
; @launch grid=(256,1,1) block=(512,1,1) lds=163840
.amdgcn_target "amdgcn-amd-amdhsa--gfx950"
.text
.globl recurrent_scan__linear_kernel_hedgehog__geglu_ffn__prompt_kernel
.p2align 8
.type recurrent_scan__linear_kernel_hedgehog__geglu_ffn__prompt_kernel,@function
recurrent_scan__linear_kernel_hedgehog__geglu_ffn__prompt_kernel:
    s_load_dwordx16 s[4:19], s[0:1], 0
    s_load_dwordx4 s[20:23], s[0:1], 64
    s_load_dwordx2 s[24:25], s[0:1], 80
    s_cmp_ge_u32 s2, 256
    s_cbranch_scc1 K1_END
    v_lshrrev_b32 v32, 6, v0
    v_and_b32 v0, 63, v0
    v_readfirstlane_b32 s56, v32
    v_lshlrev_b32 v1, 4, v0
    s_and_b32 s68, s2, 7
    s_lshr_b32 s69, s2, 3
    s_and_b32 s70, s69, 7
    s_lshr_b32 s71, s69, 3
    s_and_b32 s72, s68, 1
    s_lshl_b32 s72, s72, 3
    s_or_b32 s59, s72, s70
    s_lshr_b32 s72, s68, 1
    s_lshl_b32 s72, s72, 2
    s_or_b32 s60, s72, s71
    s_lshl_b32 s72, s71, 1
    s_add_u32 s72, s72, s70
    s_and_b32 s61, s72, 7
    s_and_b32 s57, s56, 3
    s_lshr_b32 s58, s56, 2
    s_lshl_b32 s3, s56, 11
    s_lshl_b32 s70, s59, 7
    s_lshl_b32 s71, s56, 4
    s_add_u32 s70, s70, s71
    v_lshrrev_b32 v34, 3, v0
    v_add_u32 v34, s70, v34
    v_lshlrev_b32 v34, 10, v34
    v_and_b32 v35, 7, v0
    v_lshrrev_b32 v36, 4, v0
    v_xor_b32 v37, v35, v36
    v_lshl_add_u32 v5, v37, 4, v34
    v_xor_b32 v37, 4, v37
    v_lshl_add_u32 v6, v37, 4, v34
    v_add_u32 v6, 7168, v6
    s_mul_i32 s68, s60, 3
    s_lshl_b32 s69, s60, 1
    s_add_u32 s69, s69, 11
    s_cmp_lt_u32 s60, 11
    s_cselect_b32 s62, s68, s69
    s_add_u32 s63, s62, 1
    s_add_u32 s68, s62, 2
    s_cmp_lt_u32 s60, 11
    s_cselect_b32 s64, s68, s63
    s_lshl_b32 s69, s60, 6
    s_lshl_b32 s70, s58, 10
    s_add_u32 s70, s70, 1024
    s_add_u32 s69, s69, s70
    s_lshl_b32 s70, s57, 4
    v_lshrrev_b32 v34, 2, v0
    v_add_u32 v35, s70, v34
    v_mul_u32_u24 v35, 3072, v35
    s_lshl_b32 s70, s58, 1
    v_and_b32 v36, 3, v0
    v_xor_b32 v37, s70, v36
    v_lshl_add_u32 v35, v37, 4, v35
    v_add_u32 v7, s69, v35
    s_waitcnt lgkmcnt(0)
    s_mov_b32 s28, s4
    s_and_b32 s29, s5, 0xffff
    s_mov_b32 s30, 0x200000
    s_mov_b32 s31, 0x00020000
    s_lshl_b32 s12, s56, 12
    s_lshl_b32 s13, s56, 10
    s_mov_b32 s40, s6
    s_and_b32 s41, s7, 0xffff
    s_mov_b32 s42, 0x180000
    s_mov_b32 s43, 0x00020000
    s_add_u32 s83, s61, 0
    s_and_b32 s83, s83, 7
    s_lshl_b32 s69, s83, 7
    s_add_u32 m0, s3, 0
    s_mul_i32 s83, s83, 196608
    buffer_load_dwordx4 v5, s[28:31], s69 offen lds
    buffer_load_dwordx4 v6, s[28:31], s69 offen offset:1024 lds
    s_add_u32 m0, s13, 16384
s_nop 0
    buffer_load_dwordx4 v7, s[40:43], s83 offen lds
    s_mov_b32 s44, s24
    s_and_b32 s45, s25, 0xffff
    s_mov_b32 s46, 0xf00000
    s_mov_b32 s47, 0x00020000
    s_cmp_eq_u32 s59, 0
    s_cbranch_scc0 K1_NOZERO
    s_lshl_b32 s68, s60, 12
    s_and_b32 s69, s56, 3
    s_lshl_b32 s69, s69, 10
    s_add_u32 s68, s68, s69
    s_lshl_b32 s69, s58, 16
    s_add_u32 s68, s68, s69
    s_add_u32 s68, s68, 8388608
    v_mov_b32 v40, 0
    v_mov_b32 v41, 0
    v_mov_b32 v42, 0
    v_mov_b32 v43, 0
    buffer_store_dwordx4 v[40:43], v1, s[44:47], s68 offen sc1
    s_lshl_b32 s68, s60, 7
    s_add_u32 s68, s68, 8519680
    v_mov_b32 v44, 0
    buffer_store_dwordx4 v[40:43], v44, s[44:47], s68 offen sc1
K1_NOZERO:
    s_add_u32 s83, s61, 1
    s_and_b32 s83, s83, 7
    s_lshl_b32 s69, s83, 7
    s_add_u32 m0, s3, 32768
    s_mul_i32 s83, s83, 196608
    buffer_load_dwordx4 v5, s[28:31], s69 offen lds
    buffer_load_dwordx4 v6, s[28:31], s69 offen offset:1024 lds
    s_add_u32 m0, s13, 49152
s_nop 0
    buffer_load_dwordx4 v7, s[40:43], s83 offen lds
    s_lshl_b32 s82, s58, 1
    s_xor_b32 s82, s82, s57
    v_and_b32 v32, 31, v0
    v_lshrrev_b32 v33, 5, v0
    v_mov_b32 v4, 0xbdd2d3e8
    v_mov_b32 v21, 0
    s_lshl_b32 s68, s57, 5
    v_add_u32 v34, s68, v32
    v_lshlrev_b32 v34, 7, v34
    v_bfe_u32 v35, v32, 1, 3
    v_xor_b32 v35, v35, v33
    s_lshl_b32 s69, s82, 1
    v_xor_b32 v35, s69, v35
    v_xor_b32 v36, 0, v35
    v_lshl_add_u32 v10, v36, 4, v34
    v_xor_b32 v36, 2, v35
    v_lshl_add_u32 v11, v36, 4, v34
    v_xor_b32 v36, 4, v35
    v_lshl_add_u32 v12, v36, 4, v34
    v_xor_b32 v36, 6, v35
    v_lshl_add_u32 v13, v36, 4, v34
    v_bfe_u32 v37, v0, 4, 1
    v_bfe_u32 v38, v0, 2, 2
    v_and_b32 v39, 1, v0
    v_bfe_u32 v40, v0, 1, 1
    v_lshl_or_b32 v39, v39, 1, v40
    v_lshl_add_u32 v40, v33, 3, v38
    v_lshlrev_b32 v40, 6, v40
    v_lshl_add_u32 v40, v39, 3, v40
    v_xor_b32 v41, s58, v37
    v_lshl_add_u32 v41, v41, 5, v40
    v_lshl_add_u32 v41, v37, 12, v41
    s_xor_b32 s68, s82, 0
    s_lshl_b32 s68, s68, 10
    v_add_u32 v14, s68, v41
    s_xor_b32 s68, s82, 1
    s_lshl_b32 s68, s68, 10
    v_add_u32 v15, s68, v41
    s_xor_b32 s68, s82, 2
    s_lshl_b32 s68, s68, 10
    v_add_u32 v16, s68, v41
    s_xor_b32 s68, s82, 3
    s_lshl_b32 s68, s68, 10
    v_add_u32 v17, s68, v41
    s_add_u32 s83, s61, 2
    s_and_b32 s83, s83, 7
    s_lshl_b32 s69, s83, 7
    s_add_u32 m0, s3, 65536
    s_mul_i32 s83, s83, 196608
    buffer_load_dwordx4 v5, s[28:31], s69 offen lds
    buffer_load_dwordx4 v6, s[28:31], s69 offen offset:1024 lds
    s_add_u32 m0, s13, 81920
s_nop 0
    buffer_load_dwordx4 v7, s[40:43], s83 offen lds
    s_lshl_b32 s68, s58, 9
    s_lshl_b32 s69, s57, 7
    s_add_u32 s68, s68, s69
    s_add_u32 s68, s68, 155648
    v_and_b32 v34, 1, v0
    v_lshlrev_b32 v34, 6, v34
    v_lshrrev_b32 v35, 4, v0
    v_lshl_add_u32 v34, v35, 4, v34
    v_add_u32 v19, s68, v34
    v_and_b32 v34, 15, v0
    v_and_b32 v35, 1, v35
    v_cmp_eq_u32 vcc, v34, v35
    v_mov_b32 v36, 0x3f803f80
s_nop 0
    v_cndmask_b32 v28, 0, v36, vcc
    v_cndmask_b32 v29, 0, v36, vcc
    v_cndmask_b32 v30, 0, v36, vcc
    v_cndmask_b32 v31, 0, v36, vcc
    s_lshl_b32 s68, s56, 7
    s_add_u32 s68, s68, 160768
    v_lshl_add_u32 v18, v33, 4, s68
    s_mov_b32 s26, 0x00030003
    s_mov_b32 s27, 0x00030003
    s_mov_b32 s48, s8
    s_and_b32 s49, s9, 0xffff
    s_mov_b32 s50, 0x4000
    s_mov_b32 s51, 0x00020000
    s_cmp_eq_u32 s58, 0
    s_cselect_b32 s36, s14, s16
    s_cselect_b32 s37, s15, s17
    s_and_b32 s37, s37, 0xffff
    s_mov_b32 s38, 1409024
    s_mov_b32 s39, 0x00020000
    v_lshrrev_b32 v34, 2, v0
    v_and_b32 v36, 3, v0
    s_lshl_b32 s70, s58, 1
    v_xor_b32 v37, s70, v36
    v_mul_u32_u24 v35, 2752, v34
    v_lshl_add_u32 v8, v37, 4, v35
    v_mul_u32_u24 v35, 3072, v34
    v_lshl_add_u32 v9, v36, 4, v35
    v_and_b32 v34, 3, v0
    v_bfe_u32 v35, v0, 2, 1
    v_bfe_u32 v36, v0, 3, 1
    v_lshl_or_b32 v34, v35, 3, v34
    v_lshl_or_b32 v34, v36, 2, v34
    v_lshlrev_b32 v34, 1, v34
    v_lshl_add_u32 v34, v33, 8, v34
    s_lshl_b32 s68, s60, 1
    s_add_u32 s68, s68, s58
    s_lshl_b32 s68, s68, 9
    buffer_load_ushort v52, v34, s[48:51], s68 offen offset:0
    buffer_load_ushort v53, v34, s[48:51], s68 offen offset:32
    buffer_load_ushort v54, v34, s[48:51], s68 offen offset:64
    buffer_load_ushort v55, v34, s[48:51], s68 offen offset:96
    buffer_load_ushort v56, v34, s[48:51], s68 offen offset:128
    buffer_load_ushort v57, v34, s[48:51], s68 offen offset:160
    buffer_load_ushort v58, v34, s[48:51], s68 offen offset:192
    buffer_load_ushort v59, v34, s[48:51], s68 offen offset:224
    s_mov_b32 s52, s18
    s_and_b32 s53, s19, 0xffff
    s_mov_b32 s54, 0x158000
    s_mov_b32 s55, 0x00020000
    s_mov_b32 s16, s10
    s_mov_b32 s17, s11
    s_lshl_b32 s5, s62, 6
    s_lshl_b32 s18, s63, 6
    s_lshl_b32 s19, s64, 6
    s_lshl_b32 s10, s60, 6
    s_and_b32 s11, s56, 3
    s_add_u32 s11, s11, s61
    s_add_u32 s4, s56, s61
    s_lshr_b32 s68, s57, 1
    s_cmp_eq_u32 s68, 1
    s_cselect_b64 s[66:67], -1, 0
    s_not_b64 s[20:21], s[66:67]
    s_lshl_b32 s68, s59, 2
    s_add_u32 s68, s68, s57
    s_mul_i32 s81, s68, 86
    s_add_u32 s81, s81, s58
    s_lshl_b32 s81, s81, 10
s_waitcnt vmcnt(14)
    s_barrier
    s_lshl_b32 s68, s59, 3
    s_add_u32 s68, s68, s56
    s_cmp_eq_u32 s68, 7
    s_cbranch_scc1 K1_SIGZ_W7
    buffer_load_dword v20, v1, s[44:47], 0 offen
    s_branch K1_SIGZ_J
    K1_SIGZ_W7:
    s_mov_b64 exec, 1
    s_lshl_b32 s68, s60, 2
    v_mov_b32 v21, s68
    v_mov_b32 v20, 1
    global_store_dword v21, v20, s[22:23] sc1
    s_mov_b64 exec, -1
    K1_SIGZ_J:
    ds_read_b128 v[128:131], v10 offset:0
    ds_read_b128 v[132:135], v11 offset:0
    ds_read_b128 v[136:139], v12 offset:0
    ds_read_b128 v[140:143], v13 offset:0
    ds_read_b64_tr_b16 v[64:65], v14 offset:16384
    ds_read_b64_tr_b16 v[66:67], v14 offset:16640
    ds_read_b64_tr_b16 v[68:69], v15 offset:16384
    ds_read_b64_tr_b16 v[70:71], v15 offset:16640
s_waitcnt lgkmcnt(7)
    v_mfma_f32_32x32x16_bf16 v[112:127], v[128:131], v[128:131], 0
    s_add_u32 s83, s61, 3
    s_and_b32 s83, s83, 7
    s_lshl_b32 s69, s83, 7
    s_add_u32 m0, s3, 98304
    s_mul_i32 s83, s83, 196608
    buffer_load_dwordx4 v5, s[28:31], s69 offen lds
    buffer_load_dwordx4 v6, s[28:31], s69 offen offset:1024 lds
    v_mfma_f32_16x16x32_bf16 v[36:39], v[128:131], v[28:31], 0
    ds_read_b64_tr_b16 v[72:73], v16 offset:16384
    ds_read_b64_tr_b16 v[74:75], v16 offset:16640
s_waitcnt lgkmcnt(8)
    v_mfma_f32_32x32x16_bf16 v[112:127], v[132:135], v[132:135], v[112:127]
    s_add_u32 m0, s13, 114688
s_nop 0
    buffer_load_dwordx4 v7, s[40:43], s83 offen lds
    v_mfma_f32_16x16x32_bf16 v[36:39], v[132:135], v[28:31], v[36:39]
    ds_read_b64_tr_b16 v[76:77], v17 offset:16384
    ds_read_b64_tr_b16 v[78:79], v17 offset:16640
s_waitcnt lgkmcnt(6)
    v_mfma_f32_32x32x16_bf16 v[80:95], v[64:67], v[128:131], 0
    v_mfma_f32_16x16x32_bf16 v[24:27], v[64:67], v[28:31], 0
s_waitcnt vmcnt(15)
s_waitcnt lgkmcnt(0)
    s_barrier
    ds_read_b128 v[144:147], v10 offset:32768
    ds_read_b128 v[148:151], v11 offset:32768
    ds_read_b128 v[152:155], v12 offset:32768
    ds_read_b128 v[156:159], v13 offset:32768
    ds_read_b64_tr_b16 v[64:65], v14 offset:49152
    ds_read_b64_tr_b16 v[66:67], v14 offset:49408
    v_mfma_f32_32x32x16_bf16 v[80:95], v[68:71], v[132:135], v[80:95]
    ds_read_b64_tr_b16 v[68:69], v15 offset:49152
    ds_read_b64_tr_b16 v[70:71], v15 offset:49408
s_waitcnt lgkmcnt(7)
    v_mfma_f32_32x32x16_bf16 v[112:127], v[144:147], v[144:147], v[112:127]
    s_add_u32 s83, s61, 4
    s_and_b32 s83, s83, 7
    s_lshl_b32 s69, s83, 7
    s_add_u32 m0, s3, 0
    s_mul_i32 s83, s83, 196608
    buffer_load_dwordx4 v5, s[28:31], s69 offen lds
    buffer_load_dwordx4 v6, s[28:31], s69 offen offset:1024 lds
    v_mfma_f32_16x16x32_bf16 v[36:39], v[144:147], v[28:31], v[36:39]
    v_mfma_f32_32x32x16_bf16 v[80:95], v[72:75], v[136:139], v[80:95]
    ds_read_b64_tr_b16 v[72:73], v16 offset:49152
    ds_read_b64_tr_b16 v[74:75], v16 offset:49408
s_waitcnt lgkmcnt(8)
    v_mfma_f32_32x32x16_bf16 v[112:127], v[148:151], v[148:151], v[112:127]
    v_mfma_f32_16x16x32_bf16 v[36:39], v[148:151], v[28:31], v[36:39]
    v_mfma_f32_32x32x16_bf16 v[80:95], v[76:79], v[140:143], v[80:95]
    s_add_u32 m0, s13, 16384
s_nop 0
    buffer_load_dwordx4 v7, s[40:43], s83 offen lds
    ds_read_b64_tr_b16 v[76:77], v17 offset:49152
    ds_read_b64_tr_b16 v[78:79], v17 offset:49408
s_waitcnt lgkmcnt(6)
    v_mfma_f32_32x32x16_bf16 v[80:95], v[64:67], v[144:147], v[80:95]
    v_mfma_f32_16x16x32_bf16 v[24:27], v[64:67], v[28:31], v[24:27]
s_waitcnt vmcnt(15)
s_waitcnt lgkmcnt(0)
    s_barrier
    v_xor_b32 v10, 0x10000, v10
    v_xor_b32 v11, 0x10000, v11
    v_xor_b32 v12, 0x10000, v12
    v_xor_b32 v13, 0x10000, v13
    v_xor_b32 v14, 0x10000, v14
    v_xor_b32 v15, 0x10000, v15
    v_xor_b32 v16, 0x10000, v16
    v_xor_b32 v17, 0x10000, v17
    ds_read_b128 v[160:163], v10 offset:0
    ds_read_b128 v[164:167], v11 offset:0
    ds_read_b128 v[168:171], v12 offset:0
    ds_read_b128 v[172:175], v13 offset:0
    ds_read_b64_tr_b16 v[64:65], v14 offset:16384
    ds_read_b64_tr_b16 v[66:67], v14 offset:16640
    v_mfma_f32_32x32x16_bf16 v[80:95], v[68:71], v[148:151], v[80:95]
    ds_read_b64_tr_b16 v[68:69], v15 offset:16384
    ds_read_b64_tr_b16 v[70:71], v15 offset:16640
s_waitcnt lgkmcnt(7)
    v_mfma_f32_32x32x16_bf16 v[112:127], v[160:163], v[160:163], v[112:127]
    s_add_u32 s83, s61, 5
    s_and_b32 s83, s83, 7
    s_lshl_b32 s69, s83, 7
    s_add_u32 m0, s3, 32768
    s_mul_i32 s83, s83, 196608
    buffer_load_dwordx4 v5, s[28:31], s69 offen lds
    buffer_load_dwordx4 v6, s[28:31], s69 offen offset:1024 lds
    v_mfma_f32_16x16x32_bf16 v[36:39], v[160:163], v[28:31], v[36:39]
    v_mfma_f32_32x32x16_bf16 v[80:95], v[72:75], v[152:155], v[80:95]
    ds_read_b64_tr_b16 v[72:73], v16 offset:16384
    ds_read_b64_tr_b16 v[74:75], v16 offset:16640
s_waitcnt lgkmcnt(8)
    v_mfma_f32_32x32x16_bf16 v[112:127], v[164:167], v[164:167], v[112:127]
    v_mfma_f32_16x16x32_bf16 v[36:39], v[164:167], v[28:31], v[36:39]
    v_mfma_f32_32x32x16_bf16 v[80:95], v[76:79], v[156:159], v[80:95]
    s_add_u32 m0, s13, 49152
s_nop 0
    buffer_load_dwordx4 v7, s[40:43], s83 offen lds
    ds_read_b64_tr_b16 v[76:77], v17 offset:16384
    ds_read_b64_tr_b16 v[78:79], v17 offset:16640
s_waitcnt lgkmcnt(6)
    v_mfma_f32_32x32x16_bf16 v[80:95], v[64:67], v[160:163], v[80:95]
    v_mfma_f32_16x16x32_bf16 v[24:27], v[64:67], v[28:31], v[24:27]
s_waitcnt vmcnt(6)
s_waitcnt lgkmcnt(0)
    s_barrier
    ds_read_b128 v[176:179], v10 offset:32768
    ds_read_b128 v[180:183], v11 offset:32768
    ds_read_b128 v[184:187], v12 offset:32768
    ds_read_b128 v[188:191], v13 offset:32768
    ds_read_b64_tr_b16 v[64:65], v14 offset:49152
    ds_read_b64_tr_b16 v[66:67], v14 offset:49408
    v_mfma_f32_32x32x16_bf16 v[80:95], v[68:71], v[164:167], v[80:95]
    ds_read_b64_tr_b16 v[68:69], v15 offset:49152
    ds_read_b64_tr_b16 v[70:71], v15 offset:49408
s_waitcnt lgkmcnt(7)
    v_mfma_f32_32x32x16_bf16 v[112:127], v[176:179], v[176:179], v[112:127]
    s_add_u32 s83, s61, 6
    s_and_b32 s83, s83, 7
    s_lshl_b32 s69, s83, 7
    s_add_u32 m0, s3, 65536
    s_mul_i32 s83, s83, 196608
    buffer_load_dwordx4 v5, s[28:31], s69 offen lds
    buffer_load_dwordx4 v6, s[28:31], s69 offen offset:1024 lds
    v_mfma_f32_16x16x32_bf16 v[36:39], v[176:179], v[28:31], v[36:39]
    v_mfma_f32_32x32x16_bf16 v[80:95], v[72:75], v[168:171], v[80:95]
    ds_read_b64_tr_b16 v[72:73], v16 offset:49152
    ds_read_b64_tr_b16 v[74:75], v16 offset:49408
s_waitcnt lgkmcnt(8)
    v_mfma_f32_32x32x16_bf16 v[112:127], v[180:183], v[180:183], v[112:127]
    v_mfma_f32_16x16x32_bf16 v[36:39], v[180:183], v[28:31], v[36:39]
    v_mfma_f32_32x32x16_bf16 v[80:95], v[76:79], v[172:175], v[80:95]
    s_add_u32 m0, s13, 81920
s_nop 0
    buffer_load_dwordx4 v7, s[40:43], s83 offen lds
    ds_read_b64_tr_b16 v[76:77], v17 offset:49152
    ds_read_b64_tr_b16 v[78:79], v17 offset:49408
s_waitcnt lgkmcnt(6)
    v_mfma_f32_32x32x16_bf16 v[80:95], v[64:67], v[176:179], v[80:95]
    v_mfma_f32_16x16x32_bf16 v[24:27], v[64:67], v[28:31], v[24:27]
s_waitcnt vmcnt(6)
s_waitcnt lgkmcnt(0)
    s_barrier
    v_xor_b32 v10, 0x10000, v10
    v_xor_b32 v11, 0x10000, v11
    v_xor_b32 v12, 0x10000, v12
    v_xor_b32 v13, 0x10000, v13
    v_xor_b32 v14, 0x10000, v14
    v_xor_b32 v15, 0x10000, v15
    v_xor_b32 v16, 0x10000, v16
    v_xor_b32 v17, 0x10000, v17
    ds_read_b128 v[192:195], v10 offset:0
    ds_read_b128 v[196:199], v11 offset:0
    ds_read_b128 v[200:203], v12 offset:0
    ds_read_b128 v[204:207], v13 offset:0
    ds_read_b64_tr_b16 v[64:65], v14 offset:16384
    ds_read_b64_tr_b16 v[66:67], v14 offset:16640
    v_mfma_f32_32x32x16_bf16 v[80:95], v[68:71], v[180:183], v[80:95]
    ds_read_b64_tr_b16 v[68:69], v15 offset:16384
    ds_read_b64_tr_b16 v[70:71], v15 offset:16640
s_waitcnt lgkmcnt(7)
    v_mfma_f32_32x32x16_bf16 v[112:127], v[192:195], v[192:195], v[112:127]
    s_add_u32 s83, s61, 7
    s_and_b32 s83, s83, 7
    s_lshl_b32 s69, s83, 7
    s_add_u32 m0, s3, 98304
    s_mul_i32 s83, s83, 196608
    buffer_load_dwordx4 v5, s[28:31], s69 offen lds
    buffer_load_dwordx4 v6, s[28:31], s69 offen offset:1024 lds
    v_mfma_f32_16x16x32_bf16 v[36:39], v[192:195], v[28:31], v[36:39]
    v_mfma_f32_32x32x16_bf16 v[80:95], v[72:75], v[184:187], v[80:95]
    ds_read_b64_tr_b16 v[72:73], v16 offset:16384
    ds_read_b64_tr_b16 v[74:75], v16 offset:16640
s_waitcnt lgkmcnt(8)
    v_mfma_f32_32x32x16_bf16 v[112:127], v[196:199], v[196:199], v[112:127]
    v_mfma_f32_16x16x32_bf16 v[36:39], v[196:199], v[28:31], v[36:39]
    v_mfma_f32_32x32x16_bf16 v[80:95], v[76:79], v[188:191], v[80:95]
    s_add_u32 m0, s13, 114688
s_nop 0
    buffer_load_dwordx4 v7, s[40:43], s83 offen lds
    ds_read_b64_tr_b16 v[76:77], v17 offset:16384
    ds_read_b64_tr_b16 v[78:79], v17 offset:16640
s_waitcnt lgkmcnt(6)
    v_mfma_f32_32x32x16_bf16 v[80:95], v[64:67], v[192:195], v[80:95]
    v_mfma_f32_16x16x32_bf16 v[24:27], v[64:67], v[28:31], v[24:27]
s_waitcnt vmcnt(6)
s_waitcnt lgkmcnt(0)
    s_barrier
    ds_read_b128 v[208:211], v10 offset:32768
    ds_read_b128 v[212:215], v11 offset:32768
    ds_read_b128 v[216:219], v12 offset:32768
    ds_read_b128 v[220:223], v13 offset:32768
    ds_read_b64_tr_b16 v[64:65], v14 offset:49152
    ds_read_b64_tr_b16 v[66:67], v14 offset:49408
    v_mfma_f32_32x32x16_bf16 v[80:95], v[68:71], v[196:199], v[80:95]
    ds_read_b64_tr_b16 v[68:69], v15 offset:49152
    ds_read_b64_tr_b16 v[70:71], v15 offset:49408
s_waitcnt lgkmcnt(7)
    v_mfma_f32_32x32x16_bf16 v[112:127], v[208:211], v[208:211], v[112:127]
    s_add_u32 s83, s11, 0
    s_and_b32 s83, s83, 7
    s_mul_i32 s83, s83, 176128
    s_add_u32 m0, s12, 0
    s_add_u32 s83, s83, s5
    buffer_load_dwordx4 v8, s[36:39], s83 offen offset:0 lds
    v_mfma_f32_16x16x32_bf16 v[36:39], v[208:211], v[28:31], v[36:39]
    v_mfma_f32_32x32x16_bf16 v[80:95], v[72:75], v[200:203], v[80:95]
    s_add_u32 s83, s83, 43008
    buffer_load_dwordx4 v8, s[36:39], s83 offen offset:1024 lds
    ds_read_b64_tr_b16 v[72:73], v16 offset:49152
    ds_read_b64_tr_b16 v[74:75], v16 offset:49408
s_waitcnt lgkmcnt(8)
    v_mfma_f32_32x32x16_bf16 v[112:127], v[212:215], v[212:215], v[112:127]
    v_mfma_f32_16x16x32_bf16 v[36:39], v[212:215], v[28:31], v[36:39]
    v_mfma_f32_32x32x16_bf16 v[80:95], v[76:79], v[204:207], v[80:95]
    s_add_u32 s83, s83, 43008
    buffer_load_dwordx4 v8, s[36:39], s83 offen offset:2048 lds
    ds_read_b64_tr_b16 v[76:77], v17 offset:49152
    ds_read_b64_tr_b16 v[78:79], v17 offset:49408
s_waitcnt lgkmcnt(6)
    v_mfma_f32_32x32x16_bf16 v[80:95], v[64:67], v[208:211], v[80:95]
    s_add_u32 s83, s83, 43008
    buffer_load_dwordx4 v8, s[36:39], s83 offen offset:3072 lds
    v_mfma_f32_16x16x32_bf16 v[24:27], v[64:67], v[28:31], v[24:27]
s_waitcnt vmcnt(7)
s_waitcnt lgkmcnt(0)
    s_barrier
    v_xor_b32 v10, 0x10000, v10
    v_xor_b32 v11, 0x10000, v11
    v_xor_b32 v12, 0x10000, v12
    v_xor_b32 v13, 0x10000, v13
    v_xor_b32 v14, 0x10000, v14
    v_xor_b32 v15, 0x10000, v15
    v_xor_b32 v16, 0x10000, v16
    v_xor_b32 v17, 0x10000, v17
    ds_read_b128 v[224:227], v10 offset:0
    ds_read_b128 v[228:231], v11 offset:0
    ds_read_b128 v[232:235], v12 offset:0
    ds_read_b128 v[236:239], v13 offset:0
    ds_read_b64_tr_b16 v[64:65], v14 offset:16384
    ds_read_b64_tr_b16 v[66:67], v14 offset:16640
    v_mfma_f32_32x32x16_bf16 v[80:95], v[68:71], v[212:215], v[80:95]
    ds_read_b64_tr_b16 v[68:69], v15 offset:16384
    ds_read_b64_tr_b16 v[70:71], v15 offset:16640
s_waitcnt lgkmcnt(7)
    v_mfma_f32_32x32x16_bf16 v[112:127], v[224:227], v[224:227], v[112:127]
    s_add_u32 s83, s11, 4
    s_and_b32 s83, s83, 7
    s_mul_i32 s83, s83, 176128
    s_add_u32 m0, s12, 32768
    s_add_u32 s83, s83, s5
    buffer_load_dwordx4 v8, s[36:39], s83 offen offset:0 lds
    v_mfma_f32_16x16x32_bf16 v[36:39], v[224:227], v[28:31], v[36:39]
    v_mfma_f32_32x32x16_bf16 v[80:95], v[72:75], v[216:219], v[80:95]
    s_add_u32 s83, s83, 43008
    buffer_load_dwordx4 v8, s[36:39], s83 offen offset:1024 lds
    ds_read_b64_tr_b16 v[72:73], v16 offset:16384
    ds_read_b64_tr_b16 v[74:75], v16 offset:16640
s_waitcnt lgkmcnt(8)
    v_mfma_f32_32x32x16_bf16 v[112:127], v[228:231], v[228:231], v[112:127]
    v_mfma_f32_16x16x32_bf16 v[36:39], v[228:231], v[28:31], v[36:39]
    v_mfma_f32_32x32x16_bf16 v[80:95], v[76:79], v[220:223], v[80:95]
    s_add_u32 s83, s83, 43008
    buffer_load_dwordx4 v8, s[36:39], s83 offen offset:2048 lds
    ds_read_b64_tr_b16 v[76:77], v17 offset:16384
    ds_read_b64_tr_b16 v[78:79], v17 offset:16640
s_waitcnt lgkmcnt(6)
    v_mfma_f32_32x32x16_bf16 v[80:95], v[64:67], v[224:227], v[80:95]
    s_add_u32 s83, s83, 43008
    buffer_load_dwordx4 v8, s[36:39], s83 offen offset:3072 lds
    v_mfma_f32_16x16x32_bf16 v[24:27], v[64:67], v[28:31], v[24:27]
s_waitcnt vmcnt(8)
s_waitcnt lgkmcnt(0)
    s_barrier
    ds_read_b128 v[240:243], v10 offset:32768
    ds_read_b128 v[244:247], v11 offset:32768
    ds_read_b128 v[248:251], v12 offset:32768
    ds_read_b128 v[252:255], v13 offset:32768
    ds_read_b64_tr_b16 v[64:65], v14 offset:49152
    ds_read_b64_tr_b16 v[66:67], v14 offset:49408
    v_mfma_f32_32x32x16_bf16 v[80:95], v[68:71], v[228:231], v[80:95]
    ds_read_b64_tr_b16 v[68:69], v15 offset:49152
    ds_read_b64_tr_b16 v[70:71], v15 offset:49408
s_waitcnt lgkmcnt(7)
    v_mfma_f32_32x32x16_bf16 v[112:127], v[240:243], v[240:243], v[112:127]
    s_add_u32 s83, s11, 0
    s_and_b32 s83, s83, 7
    s_mul_i32 s83, s83, 176128
    s_add_u32 m0, s12, 65536
    s_add_u32 s83, s83, s18
    buffer_load_dwordx4 v8, s[36:39], s83 offen offset:0 lds
    v_mfma_f32_16x16x32_bf16 v[36:39], v[240:243], v[28:31], v[36:39]
    v_mfma_f32_32x32x16_bf16 v[80:95], v[72:75], v[232:235], v[80:95]
    s_add_u32 s83, s83, 43008
    buffer_load_dwordx4 v8, s[36:39], s83 offen offset:1024 lds
    ds_read_b64_tr_b16 v[72:73], v16 offset:49152
    ds_read_b64_tr_b16 v[74:75], v16 offset:49408
s_waitcnt lgkmcnt(8)
    v_mfma_f32_32x32x16_bf16 v[112:127], v[244:247], v[244:247], v[112:127]
    v_mfma_f32_16x16x32_bf16 v[36:39], v[244:247], v[28:31], v[36:39]
    v_mfma_f32_32x32x16_bf16 v[80:95], v[76:79], v[236:239], v[80:95]
    s_add_u32 s83, s83, 43008
    buffer_load_dwordx4 v8, s[36:39], s83 offen offset:2048 lds
    ds_read_b64_tr_b16 v[76:77], v17 offset:49152
    ds_read_b64_tr_b16 v[78:79], v17 offset:49408
s_waitcnt lgkmcnt(6)
    v_mfma_f32_32x32x16_bf16 v[80:95], v[64:67], v[240:243], v[80:95]
    s_add_u32 s83, s83, 43008
    buffer_load_dwordx4 v8, s[36:39], s83 offen offset:3072 lds
    v_mfma_f32_16x16x32_bf16 v[24:27], v[64:67], v[28:31], v[24:27]
    s_mov_b64 exec, s[26:27]
s_nop 6
    ds_write_b128 v19, v[24:27] offset:0
    s_mov_b64 exec, -1
    v_and_b32 v40, 1, v0
    v_lshlrev_b32 v40, 6, v40
    v_lshrrev_b32 v41, 4, v0
    v_lshl_add_u32 v40, v41, 4, v40
    s_lshl_b32 s78, s56, 7
    s_add_u32 s78, s78, 160768
    v_add_u32 v40, s78, v40
    s_mov_b64 exec, s[26:27]
    ds_write_b128 v40, v[36:39]
    s_mov_b64 exec, -1
    v_and_b32 v41, 31, v0
    v_lshl_add_u32 v42, v41, 2, s78
    ds_read_b32 v20, v42
    v_bfe_u32 v43, v0, 0, 1
    v_cmp_eq_u32 s[6:7], 1, v43
    v_bfe_u32 v43, v0, 1, 1
    v_cmp_eq_u32 s[8:9], 1, v43
    v_bfe_u32 v43, v0, 3, 1
    v_cmp_eq_u32 s[14:15], 1, v43
    v_bfe_u32 v43, v0, 4, 1
    v_cmp_eq_u32 vcc, 1, v43
    v_cndmask_b32 v112, v112, v113, s[6:7]
    v_cndmask_b32 v114, v114, v115, s[6:7]
    v_cndmask_b32 v116, v116, v117, s[6:7]
    v_cndmask_b32 v118, v118, v119, s[6:7]
    v_cndmask_b32 v120, v120, v121, s[6:7]
    v_cndmask_b32 v122, v122, v123, s[6:7]
    v_cndmask_b32 v124, v124, v125, s[6:7]
    v_cndmask_b32 v126, v126, v127, s[6:7]
    v_cndmask_b32 v112, v112, v114, s[8:9]
    v_cndmask_b32 v116, v116, v118, s[8:9]
    v_cndmask_b32 v120, v120, v122, s[8:9]
    v_cndmask_b32 v124, v124, v126, s[8:9]
    v_cndmask_b32 v112, v112, v116, s[14:15]
    v_cndmask_b32 v120, v120, v124, s[14:15]
    v_cndmask_b32 v112, v112, v120, vcc
    v_bfe_u32 v43, v0, 2, 1
    v_lshrrev_b32 v44, 5, v0
    v_cmp_eq_u32 vcc, v43, v44
s_nop 1
    v_cndmask_b32 v21, 0, v112, vcc
    v_mov_b32 v43, v21
s_nop 1
    v_permlane32_swap_b32 v21, v43
    v_add_f32 v21, v21, v43
    s_lshl_b32 s78, s56, 8
    s_add_u32 s78, s78, 161792
    v_lshl_add_u32 v42, v41, 3, s78
s_waitcnt lgkmcnt(0)
    ds_write_b64 v42, v[20:21]
s_waitcnt vmcnt(8)
s_waitcnt lgkmcnt(0)
    s_barrier
    v_xor_b32 v14, 0x10000, v14
    v_xor_b32 v15, 0x10000, v15
    v_xor_b32 v16, 0x10000, v16
    v_xor_b32 v17, 0x10000, v17
    v_bfe_u32 v5, v0, 4, 1
    v_mul_u32_u24 v5, 12288, v5
    v_add_u32 v14, v14, v5
    v_add_u32 v15, v15, v5
    v_add_u32 v16, v16, v5
    v_add_u32 v17, v17, v5
    ds_read_b64_tr_b16 v[64:65], v14 offset:0
    ds_read_b64_tr_b16 v[66:67], v14 offset:256
    v_mfma_f32_32x32x16_bf16 v[80:95], v[68:71], v[244:247], v[80:95]
    ds_read_b64_tr_b16 v[68:69], v15 offset:0
    ds_read_b64_tr_b16 v[70:71], v15 offset:256
    v_mfma_f32_32x32x16_bf16 v[80:95], v[72:75], v[248:251], v[80:95]
    s_add_u32 s83, s11, 4
    s_and_b32 s83, s83, 7
    s_mul_i32 s83, s83, 176128
    s_add_u32 m0, s12, 98304
    s_add_u32 s83, s83, s18
    buffer_load_dwordx4 v8, s[36:39], s83 offen offset:0 lds
    ds_read_b64_tr_b16 v[72:73], v16 offset:0
    ds_read_b64_tr_b16 v[74:75], v16 offset:256
    v_mfma_f32_32x32x16_bf16 v[80:95], v[76:79], v[252:255], v[80:95]
    ds_read_b64_tr_b16 v[76:77], v17 offset:0
    ds_read_b64_tr_b16 v[78:79], v17 offset:256
s_waitcnt lgkmcnt(6)
    v_mfma_f32_32x32x16_bf16 v[96:111], v[64:67], v[128:131], 0
    v_mfma_f32_16x16x32_bf16 v[24:27], v[64:67], v[28:31], 0
    v_and_b32 v40, 31, v0
    s_xor_b32 s78, s56, 4
    s_lshl_b32 s78, s78, 8
    s_add_u32 s78, s78, 161792
    v_lshl_add_u32 v40, v40, 3, s78
    ds_read_b64 v[22:23], v40
    v_lshl_or_b32 v10, v53, 16, v52
    v_lshl_or_b32 v11, v55, 16, v54
    v_lshl_or_b32 v12, v57, 16, v56
    v_lshl_or_b32 v13, v59, 16, v58
    v_bfe_u32 v40, v0, 4, 1
    v_mul_u32_u24 v40, 0x8000, v40
    v_lshl_or_b32 v40, v40, 16, v40
    v_xor_b32 v10, v10, v40
    v_xor_b32 v11, v11, v40
    v_xor_b32 v12, v12, v40
    v_xor_b32 v13, v13, v40
s_waitcnt lgkmcnt(0)
    v_add_f32 v20, v20, v22
    ds_read_b64_tr_b16 v[64:65], v14 offset:4096
    ds_read_b64_tr_b16 v[66:67], v14 offset:4352
    v_mfma_f32_32x32x16_bf16 v[96:111], v[68:71], v[132:135], v[96:111]
    v_add_f32 v22, v21, v23
    v_mul_f32 v20, 0x3b000000, v20
    v_mul_f32 v22, 0x3b000000, v22
    v_fma_f32 v22, -v20, v20, v22
    v_max_f32 v22, 0, v22
    v_cvt_pk_bf16_f32 v40, v20, v22
    v_lshlrev_b32 v20, 16, v40
    v_and_b32 v22, 0xffff0000, v40
    v_add_f32 v22, 0x3727c5ac, v22
    v_cvt_pk_bf16_f32 v40, v22, v22
    v_and_b32 v22, 0xffff0000, v40
    v_sqrt_f32 v22, v22
s_nop 0
    v_cvt_pk_bf16_f32 v40, v22, v22
    v_and_b32 v22, 0xffff0000, v40
    v_rcp_f32 v2, v22
s_nop 0
    v_mul_f32 v3, v20, v2
    v_sub_f32 v3, 0, v3
s_nop 1
    s_cmp_eq_u32 s56, 7
    s_cbranch_scc1 K1_FLG_I_W7
    buffer_load_dword v20, v1, s[44:47], 0 offen
    s_branch K1_FLG_I_J
    K1_FLG_I_W7:
    s_mov_b64 exec, 0xffff
    v_lshlrev_b32 v21, 2, v0
    global_load_dword v20, v21, s[22:23] sc1
    s_mov_b64 exec, -1
    K1_FLG_I_J:
    ds_read_b64_tr_b16 v[68:69], v15 offset:4096
    ds_read_b64_tr_b16 v[70:71], v15 offset:4352
    v_mfma_f32_32x32x16_bf16 v[96:111], v[72:75], v[136:139], v[96:111]
    v_and_b32 v40, 31, v0
    s_lshl_b32 s78, s58, 9
    s_add_u32 s78, s78, 155648
    v_lshl_add_u32 v41, v40, 2, s78
    ds_read2_b32 v[32:33], v41 offset0:0 offset1:32
    ds_read2_b32 v[34:35], v41 offset0:64 offset1:96
    s_lshl_b32 s78, s56, 7
    s_add_u32 s78, s78, 160768
    v_lshl_add_u32 v40, v40, 2, s78
    s_add_u32 s83, s83, 43008
    buffer_load_dwordx4 v8, s[36:39], s83 offen offset:1024 lds
    ds_read_b64_tr_b16 v[72:73], v16 offset:4096
    ds_read_b64_tr_b16 v[74:75], v16 offset:4352
    v_mfma_f32_32x32x16_bf16 v[96:111], v[76:79], v[140:143], v[96:111]
    ds_read_b64_tr_b16 v[76:77], v17 offset:4096
    ds_read_b64_tr_b16 v[78:79], v17 offset:4352
s_waitcnt lgkmcnt(8)
    v_mfma_f32_32x32x16_bf16 v[96:111], v[64:67], v[144:147], v[96:111]
s_waitcnt lgkmcnt(5)
    v_add_f32 v32, v32, v33
s_waitcnt lgkmcnt(4)
    v_add_f32 v34, v34, v35
    v_add_f32 v32, v32, v34
    ds_write_b32 v40, v32
    ds_read_b128 v[32:35], v18 offset:0
    ds_read_b128 v[36:39], v18 offset:32
    ds_read_b128 v[40:43], v18 offset:64
    ds_read_b128 v[44:47], v18 offset:96
    v_mfma_f32_16x16x32_bf16 v[24:27], v[64:67], v[28:31], v[24:27]
    ds_read_b64_tr_b16 v[64:65], v14 offset:8192
    ds_read_b64_tr_b16 v[66:67], v14 offset:8448
    v_mfma_f32_32x32x16_bf16 v[96:111], v[68:71], v[148:151], v[96:111]
s_waitcnt lgkmcnt(5)
    v_mul_f32 v32, v32, v3
    v_fma_f32 v80, v80, v2, v32
    v_mul_f32 v33, v33, v3
    v_fma_f32 v81, v81, v2, v33
    v_mul_f32 v34, v34, v3
    v_fma_f32 v82, v82, v2, v34
    v_mul_f32 v35, v35, v3
    v_fma_f32 v83, v83, v2, v35
s_waitcnt lgkmcnt(4)
    v_mul_f32 v36, v36, v3
    v_fma_f32 v84, v84, v2, v36
    v_mul_f32 v37, v37, v3
    v_fma_f32 v85, v85, v2, v37
    v_mul_f32 v38, v38, v3
    v_fma_f32 v86, v86, v2, v38
    v_mul_f32 v39, v39, v3
    v_fma_f32 v87, v87, v2, v39
s_waitcnt lgkmcnt(3)
    v_mul_f32 v40, v40, v3
    v_fma_f32 v88, v88, v2, v40
    ds_read_b64_tr_b16 v[68:69], v15 offset:8192
    ds_read_b64_tr_b16 v[70:71], v15 offset:8448
    v_mfma_f32_32x32x16_bf16 v[96:111], v[72:75], v[152:155], v[96:111]
    v_mul_f32 v41, v41, v3
    v_fma_f32 v89, v89, v2, v41
    v_mul_f32 v42, v42, v3
    v_fma_f32 v90, v90, v2, v42
    v_mul_f32 v43, v43, v3
    v_fma_f32 v91, v91, v2, v43
s_waitcnt lgkmcnt(4)
    v_mul_f32 v44, v44, v3
    v_fma_f32 v92, v92, v2, v44
    v_mul_f32 v45, v45, v3
    v_fma_f32 v93, v93, v2, v45
    v_mul_f32 v46, v46, v3
    v_fma_f32 v94, v94, v2, v46
    v_mul_f32 v47, v47, v3
    v_fma_f32 v95, v95, v2, v47
    v_cvt_pk_bf16_f32 v48, v80, v81
    v_cvt_pk_bf16_f32 v49, v82, v83
    v_cvt_pk_bf16_f32 v50, v84, v85
    v_cvt_pk_bf16_f32 v51, v86, v87
    s_add_u32 s83, s83, 43008
    buffer_load_dwordx4 v8, s[36:39], s83 offen offset:2048 lds
    ds_read_b64_tr_b16 v[72:73], v16 offset:8192
    ds_read_b64_tr_b16 v[74:75], v16 offset:8448
    v_mfma_f32_32x32x16_bf16 v[96:111], v[76:79], v[156:159], v[96:111]
    v_mfma_f32_32x32x16_bf16 v[32:47], v[10:13], v[48:51], 0
    v_cvt_pk_bf16_f32 v52, v88, v89
    v_cvt_pk_bf16_f32 v53, v90, v91
    v_cvt_pk_bf16_f32 v54, v92, v93
    v_cvt_pk_bf16_f32 v55, v94, v95
    v_and_b32 v56, 31, v0
    s_lshl_b32 s76, s57, 5
    v_add_u32 v56, s76, v56
    v_lshrrev_b32 v57, 5, v0
    v_lshlrev_b32 v57, 4, v57
    v_lshl_add_u32 v58, v56, 5, v57
    s_lshl_b32 s76, s58, 12
    s_add_u32 s76, s76, 147456
    v_add_u32 v58, s76, v58
    ds_write_b128 v58, v[52:55]
    v_lshl_add_u32 v58, v56, 6, v57
    s_lshl_b32 s76, s58, 13
    s_add_u32 s76, s76, 131072
    ds_read_b64_tr_b16 v[76:77], v17 offset:8192
    ds_read_b64_tr_b16 v[78:79], v17 offset:8448
s_waitcnt lgkmcnt(7)
    v_mfma_f32_32x32x16_bf16 v[96:111], v[64:67], v[160:163], v[96:111]
    v_add_u32 v59, s76, v58
    v_max3_f32 v60, v32, v33, v34
    v_max3_f32 v61, v35, v36, v37
    v_max3_f32 v60, v60, v38, v39
    v_max_f32 v60, v60, v61
    v_mov_b32 v61, v60
s_nop 1
    v_permlane32_swap_b32 v60, v61
    v_max_f32 v60, v60, v61
    v_mul_f32 v60, 0xbfb8aa3b, v60
    v_mov_b32 v62, 0x3fb8aa3b
    v_fma_f32 v32, v32, v62, v60
    v_fma_f32 v33, v33, v62, v60
    v_fma_f32 v34, v34, v62, v60
    v_fma_f32 v35, v35, v62, v60
    v_fma_f32 v36, v36, v62, v60
    v_fma_f32 v37, v37, v62, v60
    v_fma_f32 v38, v38, v62, v60
    v_fma_f32 v39, v39, v62, v60
    v_mfma_f32_16x16x32_bf16 v[24:27], v[64:67], v[28:31], v[24:27]
    v_exp_f32 v32, v32
    v_exp_f32 v33, v33
    v_exp_f32 v34, v34
    v_exp_f32 v35, v35
    v_exp_f32 v36, v36
    v_exp_f32 v37, v37
    v_exp_f32 v38, v38
    v_exp_f32 v39, v39
    v_add_f32 v62, v32, v33
    v_add_f32 v61, v34, v35
    v_add_f32 v62, v62, v36
    v_add_f32 v61, v61, v37
    v_add_f32 v62, v62, v38
    v_add_f32 v61, v61, v39
    v_add_f32 v62, v62, v61
    v_mov_b32 v61, v62
s_nop 1
    v_permlane32_swap_b32 v62, v61
    v_add_f32 v62, v62, v61
    ds_read_b64_tr_b16 v[64:65], v14 offset:12288
    ds_read_b64_tr_b16 v[66:67], v14 offset:12544
s_waitcnt lgkmcnt(7)
    v_mfma_f32_32x32x16_bf16 v[96:111], v[68:71], v[164:167], v[96:111]
    v_rcp_f32 v62, v62
s_nop 0
    v_mul_f32 v32, v32, v62
    v_mul_f32 v33, v33, v62
    v_mul_f32 v34, v34, v62
    v_mul_f32 v35, v35, v62
    v_mul_f32 v36, v36, v62
    v_mul_f32 v37, v37, v62
    v_mul_f32 v38, v38, v62
    v_mul_f32 v39, v39, v62
    v_cvt_pk_bf16_f32 v48, v32, v33
    v_cvt_pk_bf16_f32 v49, v34, v35
    v_cvt_pk_bf16_f32 v50, v36, v37
    v_cvt_pk_bf16_f32 v51, v38, v39
    ds_write_b128 v59, v[48:51]
    v_max3_f32 v60, v40, v41, v42
    v_max3_f32 v61, v43, v44, v45
    v_max3_f32 v60, v60, v46, v47
    v_max_f32 v60, v60, v61
    ds_read_b64_tr_b16 v[68:69], v15 offset:12288
    ds_read_b64_tr_b16 v[70:71], v15 offset:12544
s_waitcnt lgkmcnt(8)
    v_mfma_f32_32x32x16_bf16 v[96:111], v[72:75], v[168:171], v[96:111]
    v_mov_b32 v61, v60
s_nop 1
    v_permlane32_swap_b32 v60, v61
    v_max_f32 v60, v60, v61
    v_mul_f32 v60, 0xbfb8aa3b, v60
    v_mov_b32 v62, 0x3fb8aa3b
    v_fma_f32 v40, v40, v62, v60
    v_fma_f32 v41, v41, v62, v60
    v_fma_f32 v42, v42, v62, v60
    v_fma_f32 v43, v43, v62, v60
    v_fma_f32 v44, v44, v62, v60
    v_fma_f32 v45, v45, v62, v60
    v_fma_f32 v46, v46, v62, v60
    v_fma_f32 v47, v47, v62, v60
    v_exp_f32 v40, v40
    v_exp_f32 v41, v41
    v_exp_f32 v42, v42
    v_exp_f32 v43, v43
    v_exp_f32 v44, v44
    s_add_u32 s83, s83, 43008
    buffer_load_dwordx4 v8, s[36:39], s83 offen offset:3072 lds
    ds_read_b64_tr_b16 v[72:73], v16 offset:12288
    ds_read_b64_tr_b16 v[74:75], v16 offset:12544
s_waitcnt lgkmcnt(7)
    v_mfma_f32_32x32x16_bf16 v[96:111], v[76:79], v[172:175], v[96:111]
    v_exp_f32 v45, v45
    v_exp_f32 v46, v46
    v_exp_f32 v47, v47
    v_add_f32 v62, v40, v41
    v_add_f32 v61, v42, v43
    v_add_f32 v62, v62, v44
    v_add_f32 v61, v61, v45
    v_add_f32 v62, v62, v46
    v_add_f32 v61, v61, v47
    v_add_f32 v62, v62, v61
    v_mov_b32 v61, v62
s_nop 1
    v_permlane32_swap_b32 v62, v61
    v_add_f32 v62, v62, v61
    v_rcp_f32 v62, v62
s_nop 0
    v_mul_f32 v40, v40, v62
    v_mul_f32 v41, v41, v62
    v_mul_f32 v42, v42, v62
    v_mul_f32 v43, v43, v62
    ds_read_b64_tr_b16 v[76:77], v17 offset:12288
    ds_read_b64_tr_b16 v[78:79], v17 offset:12544
s_waitcnt lgkmcnt(7)
    v_mfma_f32_32x32x16_bf16 v[96:111], v[64:67], v[176:179], v[96:111]
    v_mul_f32 v44, v44, v62
    v_mul_f32 v45, v45, v62
    v_mul_f32 v46, v46, v62
    v_mul_f32 v47, v47, v62
    v_cvt_pk_bf16_f32 v52, v40, v41
    v_cvt_pk_bf16_f32 v53, v42, v43
    v_cvt_pk_bf16_f32 v54, v44, v45
    v_cvt_pk_bf16_f32 v55, v46, v47
    ds_write_b128 v59, v[52:55] offset:32
    v_mfma_f32_16x16x32_bf16 v[24:27], v[64:67], v[28:31], v[24:27]
s_waitcnt vmcnt(9)
s_waitcnt vmcnt(3)
    s_cmp_eq_u32 s56, 7
    s_cbranch_scc0 K1_FLG_OK
    s_mov_b32 s79, 0
    s_mov_b64 exec, 0xffff
    s_branch K1_FLG_CHK
    K1_FLG_POLL:
    s_sleep 8
    global_load_dword v20, v21, s[22:23] sc1
    s_waitcnt vmcnt(0)
    K1_FLG_CHK:
    s_add_u32 s79, s79, 1
    v_cmp_eq_u32 vcc, 0, v20
    s_nop 4
    s_cbranch_vccz K1_FLG_DONE
    s_cmp_lt_u32 s79, 20000
    s_cbranch_scc1 K1_FLG_POLL
    K1_FLG_DONE:
    s_mov_b64 exec, -1
K1_FLG_OK:
s_waitcnt lgkmcnt(0)
    s_barrier
    ds_read_b64_tr_b16 v[64:65], v14 offset:32768
    ds_read_b64_tr_b16 v[66:67], v14 offset:33024
    v_mfma_f32_32x32x16_bf16 v[96:111], v[68:71], v[180:183], v[96:111]
    v_lshrrev_b32 v48, 4, v0
    v_bfe_u32 v49, v0, 2, 2
    v_lshl_add_u32 v48, v48, 3, v49
    v_and_b32 v49, 3, v0
    ds_read_b64_tr_b16 v[68:69], v15 offset:32768
    ds_read_b64_tr_b16 v[70:71], v15 offset:33024
    v_mfma_f32_32x32x16_bf16 v[96:111], v[72:75], v[184:187], v[96:111]
    v_lshlrev_b32 v49, 3, v49
    v_lshl_add_u32 v32, v48, 6, v49
    v_lshl_add_u32 v33, v48, 5, v49
    s_and_b32 s76, s57, 1
    s_add_u32 s83, s11, 0
    s_and_b32 s83, s83, 7
    s_mul_i32 s83, s83, 176128
    s_add_u32 m0, s12, 0
    s_add_u32 s83, s83, s19
    buffer_load_dwordx4 v8, s[36:39], s83 offen offset:0 lds
    ds_read_b64_tr_b16 v[72:73], v16 offset:32768
    ds_read_b64_tr_b16 v[74:75], v16 offset:33024
    v_mfma_f32_32x32x16_bf16 v[96:111], v[76:79], v[188:191], v[96:111]
    s_lshl_b32 s76, s76, 5
    s_lshl_b32 s77, s58, 13
    s_add_u32 s76, s76, s77
    s_add_u32 s76, s76, 131072
    ds_read_b64_tr_b16 v[76:77], v17 offset:32768
    ds_read_b64_tr_b16 v[78:79], v17 offset:33024
s_waitcnt lgkmcnt(6)
    v_mfma_f32_32x32x16_bf16 v[96:111], v[64:67], v[192:195], v[96:111]
    v_add_u32 v32, s76, v32
    s_lshl_b32 s77, s58, 12
    s_add_u32 s77, s77, 147456
    v_add_u32 v33, s77, v33
    v_mfma_f32_16x16x32_bf16 v[24:27], v[64:67], v[28:31], v[24:27]
    v_mov_b32 v50, 0x3f803f80
    ds_read_b64_tr_b16 v[40:41], v32 offset:0
    ds_read_b64_tr_b16 v[44:45], v33 offset:0
    ds_read_b64_tr_b16 v[42:43], v32 offset:256
    ds_read_b64_tr_b16 v[64:65], v14 offset:36864
    ds_read_b64_tr_b16 v[66:67], v14 offset:37120
s_waitcnt lgkmcnt(9)
    v_mfma_f32_32x32x16_bf16 v[96:111], v[68:71], v[196:199], v[96:111]
    ds_read_b64_tr_b16 v[46:47], v33 offset:128
s_waitcnt lgkmcnt(4)
    v_cndmask_b32 v44, v44, v50, s[66:67]
    v_cndmask_b32 v45, v45, v50, s[66:67]
s_waitcnt lgkmcnt(0)
    v_cndmask_b32 v46, v46, v50, s[66:67]
    ds_read_b64_tr_b16 v[68:69], v15 offset:36864
    ds_read_b64_tr_b16 v[70:71], v15 offset:37120
    v_mfma_f32_32x32x16_bf16 v[96:111], v[72:75], v[200:203], v[96:111]
    v_cndmask_b32 v47, v47, v50, s[66:67]
s_nop 1
    v_mfma_f32_16x16x32_bf16 v[36:39], v[40:43], v[44:47], 0
    ds_read_b64_tr_b16 v[52:53], v32 offset:2048
    ds_read_b64_tr_b16 v[56:57], v33 offset:1024
    s_add_u32 s83, s83, 43008
    buffer_load_dwordx4 v8, s[36:39], s83 offen offset:1024 lds
    ds_read_b64_tr_b16 v[72:73], v16 offset:36864
    ds_read_b64_tr_b16 v[74:75], v16 offset:37120
    v_mfma_f32_32x32x16_bf16 v[96:111], v[76:79], v[204:207], v[96:111]
    ds_read_b64_tr_b16 v[54:55], v32 offset:2304
    ds_read_b64_tr_b16 v[58:59], v33 offset:1152
s_waitcnt lgkmcnt(4)
    v_cndmask_b32 v56, v56, v50, s[66:67]
    v_cndmask_b32 v57, v57, v50, s[66:67]
    ds_read_b64_tr_b16 v[76:77], v17 offset:36864
    ds_read_b64_tr_b16 v[78:79], v17 offset:37120
    v_mfma_f32_32x32x16_bf16 v[96:111], v[64:67], v[208:211], v[96:111]
s_waitcnt lgkmcnt(2)
    v_cndmask_b32 v58, v58, v50, s[66:67]
    v_cndmask_b32 v59, v59, v50, s[66:67]
s_nop 1
    v_mfma_f32_16x16x32_bf16 v[36:39], v[52:55], v[56:59], v[36:39]
    ds_read_b64_tr_b16 v[40:41], v32 offset:4096
    v_mfma_f32_16x16x32_bf16 v[24:27], v[64:67], v[28:31], v[24:27]
    ds_read_b64_tr_b16 v[44:45], v33 offset:2048
    ds_read_b64_tr_b16 v[42:43], v32 offset:4352
    ds_read_b64_tr_b16 v[46:47], v33 offset:2176
s_waitcnt lgkmcnt(2)
    v_cndmask_b32 v44, v44, v50, s[66:67]
    ds_read_b64_tr_b16 v[64:65], v14 offset:40960
    ds_read_b64_tr_b16 v[66:67], v14 offset:41216
    v_mfma_f32_32x32x16_bf16 v[96:111], v[68:71], v[212:215], v[96:111]
    v_cndmask_b32 v45, v45, v50, s[66:67]
s_waitcnt lgkmcnt(2)
    v_cndmask_b32 v46, v46, v50, s[66:67]
    v_cndmask_b32 v47, v47, v50, s[66:67]
s_nop 1
    v_mfma_f32_16x16x32_bf16 v[36:39], v[40:43], v[44:47], v[36:39]
    ds_read_b64_tr_b16 v[68:69], v15 offset:40960
    ds_read_b64_tr_b16 v[70:71], v15 offset:41216
    v_mfma_f32_32x32x16_bf16 v[96:111], v[72:75], v[216:219], v[96:111]
    ds_read_b64_tr_b16 v[52:53], v32 offset:6144
    ds_read_b64_tr_b16 v[56:57], v33 offset:3072
    ds_read_b64_tr_b16 v[54:55], v32 offset:6400
    ds_read_b64_tr_b16 v[58:59], v33 offset:3200
    s_add_u32 s83, s83, 43008
    buffer_load_dwordx4 v8, s[36:39], s83 offen offset:2048 lds
    ds_read_b64_tr_b16 v[72:73], v16 offset:40960
    ds_read_b64_tr_b16 v[74:75], v16 offset:41216
    v_mfma_f32_32x32x16_bf16 v[96:111], v[76:79], v[220:223], v[96:111]
s_waitcnt lgkmcnt(4)
    v_cndmask_b32 v56, v56, v50, s[66:67]
    v_cndmask_b32 v57, v57, v50, s[66:67]
s_waitcnt lgkmcnt(2)
    v_cndmask_b32 v58, v58, v50, s[66:67]
    v_cndmask_b32 v59, v59, v50, s[66:67]
    ds_read_b64_tr_b16 v[76:77], v17 offset:40960
    ds_read_b64_tr_b16 v[78:79], v17 offset:41216
    v_mfma_f32_32x32x16_bf16 v[96:111], v[64:67], v[224:227], v[96:111]
    v_mfma_f32_16x16x32_bf16 v[36:39], v[52:55], v[56:59], v[36:39]
    s_lshl_b32 s76, s60, 1
    s_add_u32 s76, s76, s58
    s_lshl_b32 s76, s76, 1
    v_mfma_f32_16x16x32_bf16 v[24:27], v[64:67], v[28:31], v[24:27]
    s_and_b32 s77, s57, 1
    s_add_u32 s76, s76, s77
    s_lshl_b32 s76, s76, 10
    s_lshr_b32 s77, s57, 1
    ds_read_b64_tr_b16 v[64:65], v14 offset:45056
    ds_read_b64_tr_b16 v[66:67], v14 offset:45312
    v_mfma_f32_32x32x16_bf16 v[96:111], v[68:71], v[228:231], v[96:111]
    s_lshl_b32 s77, s77, 16
    s_add_u32 s76, s76, s77
    s_add_u32 s76, s76, 8388608
    v_lshlrev_b32 v48, 2, v0
    ds_read_b64_tr_b16 v[68:69], v15 offset:45056
    ds_read_b64_tr_b16 v[70:71], v15 offset:45312
s_waitcnt lgkmcnt(6)
    v_mfma_f32_32x32x16_bf16 v[96:111], v[72:75], v[232:235], v[96:111]
    s_mov_b32 s74, 0x00010001
    s_mov_b32 s75, 0x00010001
    s_or_b64 s[74:75], s[74:75], s[20:21]
    s_mov_b64 exec, s[74:75]
    buffer_atomic_add_f32 v36, v48, s[44:47], s76 offen offset:0
    buffer_atomic_add_f32 v37, v48, s[44:47], s76 offen offset:256
    buffer_atomic_add_f32 v38, v48, s[44:47], s76 offen offset:512
    buffer_atomic_add_f32 v39, v48, s[44:47], s76 offen offset:768
    s_mov_b64 exec, -1
    s_add_u32 s83, s83, 43008
    buffer_load_dwordx4 v8, s[36:39], s83 offen offset:3072 lds
    ds_read_b64_tr_b16 v[72:73], v16 offset:45056
    ds_read_b64_tr_b16 v[74:75], v16 offset:45312
s_waitcnt lgkmcnt(6)
    v_mfma_f32_32x32x16_bf16 v[96:111], v[76:79], v[236:239], v[96:111]
    ds_read_b64_tr_b16 v[76:77], v17 offset:45056
    ds_read_b64_tr_b16 v[78:79], v17 offset:45312
s_waitcnt lgkmcnt(6)
    v_mfma_f32_32x32x16_bf16 v[96:111], v[64:67], v[240:243], v[96:111]
    v_mfma_f32_16x16x32_bf16 v[24:27], v[64:67], v[28:31], v[24:27]
    s_mov_b64 exec, s[26:27]
s_nop 6
    ds_write_b128 v19, v[24:27] offset:1024
    s_mov_b64 exec, -1
s_waitcnt lgkmcnt(0)
    s_barrier
    v_xor_b32 v14, 0x10000, v14
    v_xor_b32 v15, 0x10000, v15
    v_xor_b32 v16, 0x10000, v16
    v_xor_b32 v17, 0x10000, v17
    ds_read_b64_tr_b16 v[64:65], v14 offset:0
    ds_read_b64_tr_b16 v[66:67], v14 offset:256
    v_mfma_f32_32x32x16_bf16 v[96:111], v[68:71], v[244:247], v[96:111]
    ds_read_b64_tr_b16 v[68:69], v15 offset:0
    ds_read_b64_tr_b16 v[70:71], v15 offset:256
    v_mfma_f32_32x32x16_bf16 v[96:111], v[72:75], v[248:251], v[96:111]
    s_add_u32 s83, s11, 4
    s_and_b32 s83, s83, 7
    s_mul_i32 s83, s83, 176128
    s_add_u32 m0, s12, 32768
    s_add_u32 s83, s83, s19
    buffer_load_dwordx4 v8, s[36:39], s83 offen offset:0 lds
    ds_read_b64_tr_b16 v[72:73], v16 offset:0
    ds_read_b64_tr_b16 v[74:75], v16 offset:256
    v_mfma_f32_32x32x16_bf16 v[96:111], v[76:79], v[252:255], v[96:111]
    ds_read_b64_tr_b16 v[76:77], v17 offset:0
    ds_read_b64_tr_b16 v[78:79], v17 offset:256
s_waitcnt lgkmcnt(6)
    v_mfma_f32_32x32x16_bf16 v[112:127], v[64:67], v[128:131], 0
    v_mfma_f32_16x16x32_bf16 v[24:27], v[64:67], v[28:31], 0
    v_and_b32 v40, 31, v0
    s_lshl_b32 s78, s58, 9
    s_add_u32 s78, s78, 156672
    v_lshl_add_u32 v41, v40, 2, s78
    ds_read2_b32 v[32:33], v41 offset0:0 offset1:32
    ds_read_b64_tr_b16 v[64:65], v14 offset:4096
    ds_read_b64_tr_b16 v[66:67], v14 offset:4352
s_waitcnt lgkmcnt(7)
    v_mfma_f32_32x32x16_bf16 v[112:127], v[68:71], v[132:135], v[112:127]
    ds_read2_b32 v[34:35], v41 offset0:64 offset1:96
    s_lshl_b32 s78, s56, 7
    s_add_u32 s78, s78, 160768
    v_lshl_add_u32 v40, v40, 2, s78
    ds_read_b64_tr_b16 v[68:69], v15 offset:4096
    ds_read_b64_tr_b16 v[70:71], v15 offset:4352
s_waitcnt lgkmcnt(8)
    v_mfma_f32_32x32x16_bf16 v[112:127], v[72:75], v[136:139], v[112:127]
    s_add_u32 s83, s83, 43008
    buffer_load_dwordx4 v8, s[36:39], s83 offen offset:1024 lds
    ds_read_b64_tr_b16 v[72:73], v16 offset:4096
    ds_read_b64_tr_b16 v[74:75], v16 offset:4352
s_waitcnt lgkmcnt(8)
    v_mfma_f32_32x32x16_bf16 v[112:127], v[76:79], v[140:143], v[112:127]
s_waitcnt lgkmcnt(7)
    v_add_f32 v32, v32, v33
s_waitcnt lgkmcnt(4)
    v_add_f32 v34, v34, v35
    v_add_f32 v32, v32, v34
    ds_write_b32 v40, v32
    ds_read_b128 v[32:35], v18 offset:0
    ds_read_b64_tr_b16 v[76:77], v17 offset:4096
    ds_read_b64_tr_b16 v[78:79], v17 offset:4352
    v_mfma_f32_32x32x16_bf16 v[112:127], v[64:67], v[144:147], v[112:127]
    ds_read_b128 v[36:39], v18 offset:32
    ds_read_b128 v[40:43], v18 offset:64
    ds_read_b128 v[44:47], v18 offset:96
    v_mfma_f32_16x16x32_bf16 v[24:27], v[64:67], v[28:31], v[24:27]
    ds_read_b64_tr_b16 v[64:65], v14 offset:8192
    ds_read_b64_tr_b16 v[66:67], v14 offset:8448
s_waitcnt lgkmcnt(11)
    v_mfma_f32_32x32x16_bf16 v[112:127], v[68:71], v[148:151], v[112:127]
s_waitcnt lgkmcnt(7)
    v_mul_f32 v32, v32, v3
    v_fma_f32 v96, v96, v2, v32
    v_mul_f32 v33, v33, v3
    v_fma_f32 v97, v97, v2, v33
    v_mul_f32 v34, v34, v3
    ds_read_b64_tr_b16 v[68:69], v15 offset:8192
    ds_read_b64_tr_b16 v[70:71], v15 offset:8448
    v_mfma_f32_32x32x16_bf16 v[112:127], v[72:75], v[152:155], v[112:127]
    v_fma_f32 v98, v98, v2, v34
    v_mul_f32 v35, v35, v3
    v_fma_f32 v99, v99, v2, v35
s_waitcnt lgkmcnt(6)
    v_mul_f32 v36, v36, v3
    v_fma_f32 v100, v100, v2, v36
    s_add_u32 s83, s83, 43008
    buffer_load_dwordx4 v8, s[36:39], s83 offen offset:2048 lds
    ds_read_b64_tr_b16 v[72:73], v16 offset:8192
    ds_read_b64_tr_b16 v[74:75], v16 offset:8448
    v_mfma_f32_32x32x16_bf16 v[112:127], v[76:79], v[156:159], v[112:127]
    v_mul_f32 v37, v37, v3
    v_fma_f32 v101, v101, v2, v37
    v_mul_f32 v38, v38, v3
    v_fma_f32 v102, v102, v2, v38
    v_mul_f32 v39, v39, v3
    ds_read_b64_tr_b16 v[76:77], v17 offset:8192
    ds_read_b64_tr_b16 v[78:79], v17 offset:8448
s_waitcnt lgkmcnt(6)
    v_mfma_f32_32x32x16_bf16 v[112:127], v[64:67], v[160:163], v[112:127]
    v_fma_f32 v103, v103, v2, v39
    v_mul_f32 v40, v40, v3
    v_fma_f32 v104, v104, v2, v40
    v_mul_f32 v41, v41, v3
    v_fma_f32 v105, v105, v2, v41
    v_mfma_f32_16x16x32_bf16 v[24:27], v[64:67], v[28:31], v[24:27]
    v_mul_f32 v42, v42, v3
    v_fma_f32 v106, v106, v2, v42
    v_mul_f32 v43, v43, v3
    v_fma_f32 v107, v107, v2, v43
    v_mul_f32 v44, v44, v3
    ds_read_b64_tr_b16 v[64:65], v14 offset:12288
    ds_read_b64_tr_b16 v[66:67], v14 offset:12544
s_waitcnt lgkmcnt(6)
    v_mfma_f32_32x32x16_bf16 v[112:127], v[68:71], v[164:167], v[112:127]
    v_fma_f32 v108, v108, v2, v44
    v_mul_f32 v45, v45, v3
    v_fma_f32 v109, v109, v2, v45
    v_mul_f32 v46, v46, v3
    v_fma_f32 v110, v110, v2, v46
    ds_read_b64_tr_b16 v[68:69], v15 offset:12288
    ds_read_b64_tr_b16 v[70:71], v15 offset:12544
s_waitcnt lgkmcnt(6)
    v_mfma_f32_32x32x16_bf16 v[112:127], v[72:75], v[168:171], v[112:127]
    v_mul_f32 v47, v47, v3
    v_fma_f32 v111, v111, v2, v47
    v_mul_f32 v32, v96, v96
    v_mul_f32 v33, v97, v97
    v_mul_f32 v34, v98, v98
    s_add_u32 s83, s83, 43008
    buffer_load_dwordx4 v8, s[36:39], s83 offen offset:3072 lds
    ds_read_b64_tr_b16 v[72:73], v16 offset:12288
    ds_read_b64_tr_b16 v[74:75], v16 offset:12544
s_waitcnt lgkmcnt(6)
    v_mfma_f32_32x32x16_bf16 v[112:127], v[76:79], v[172:175], v[112:127]
    v_mul_f32 v35, v99, v99
    v_mul_f32 v36, v100, v100
    v_mul_f32 v37, v101, v101
    v_mul_f32 v38, v102, v102
    v_mul_f32 v39, v103, v103
    ds_read_b64_tr_b16 v[76:77], v17 offset:12288
    ds_read_b64_tr_b16 v[78:79], v17 offset:12544
s_waitcnt lgkmcnt(6)
    v_mfma_f32_32x32x16_bf16 v[112:127], v[64:67], v[176:179], v[112:127]
    v_fmaak_f32 v32, v32, v4, 0xc0135761
    v_fmaak_f32 v33, v33, v4, 0xc0135761
    v_mfma_f32_16x16x32_bf16 v[24:27], v[64:67], v[28:31], v[24:27]
s_waitcnt vmcnt(12)
s_waitcnt vmcnt(5)
s_waitcnt lgkmcnt(0)
    s_barrier
s_nop 4
    s_cmp_eq_u32 s56, 7
    s_cbranch_scc1 K1_SIGK_W7
    buffer_load_dword v20, v1, s[44:47], 0 offen
    s_branch K1_SIGK_J
    K1_SIGK_W7:
    s_mov_b64 exec, 1
    s_lshl_b32 s68, s60, 7
    s_add_u32 s68, s68, 8519680
    v_mov_b32 v21, 0
    v_mov_b32 v20, 1
    buffer_atomic_add v20, v21, s[44:47], s68 offen sc1
    s_mov_b64 exec, -1
    K1_SIGK_J:
    ds_read_b64_tr_b16 v[64:65], v14 offset:32768
    ds_read_b64_tr_b16 v[66:67], v14 offset:33024
    v_mfma_f32_32x32x16_bf16 v[112:127], v[68:71], v[180:183], v[112:127]
    v_fmaak_f32 v34, v34, v4, 0xc0135761
    v_fmaak_f32 v35, v35, v4, 0xc0135761
    v_fmaak_f32 v36, v36, v4, 0xc0135761
    v_fmaak_f32 v37, v37, v4, 0xc0135761
    ds_read_b64_tr_b16 v[68:69], v15 offset:32768
    ds_read_b64_tr_b16 v[70:71], v15 offset:33024
    v_mfma_f32_32x32x16_bf16 v[112:127], v[72:75], v[184:187], v[112:127]
    v_fmaak_f32 v38, v38, v4, 0xc0135761
    v_fmaak_f32 v39, v39, v4, 0xc0135761
    v_mul_f32 v32, v32, v96
    v_mul_f32 v33, v33, v97
    s_add_u32 s83, s4, 0
    s_and_b32 s83, s83, 7
    s_mul_i32 s83, s83, 196608
    s_add_u32 m0, s12, 65536
    s_add_u32 s83, s83, s10
    buffer_load_dwordx4 v9, s[40:43], s83 offen offset:0 lds
    ds_read_b64_tr_b16 v[72:73], v16 offset:32768
    ds_read_b64_tr_b16 v[74:75], v16 offset:33024
    v_mfma_f32_32x32x16_bf16 v[112:127], v[76:79], v[188:191], v[112:127]
    v_mul_f32 v34, v34, v98
    v_mul_f32 v35, v35, v99
    v_mul_f32 v36, v36, v100
    v_mul_f32 v37, v37, v101
    ds_read_b64_tr_b16 v[76:77], v17 offset:32768
    ds_read_b64_tr_b16 v[78:79], v17 offset:33024
s_waitcnt lgkmcnt(6)
    v_mfma_f32_32x32x16_bf16 v[112:127], v[64:67], v[192:195], v[112:127]
    v_mul_f32 v38, v38, v102
    v_mul_f32 v39, v39, v103
    v_exp_f32 v32, v32
    v_exp_f32 v33, v33
    v_mfma_f32_16x16x32_bf16 v[24:27], v[64:67], v[28:31], v[24:27]
    v_exp_f32 v34, v34
    v_exp_f32 v35, v35
    v_exp_f32 v36, v36
    v_exp_f32 v37, v37
    ds_read_b64_tr_b16 v[64:65], v14 offset:36864
    ds_read_b64_tr_b16 v[66:67], v14 offset:37120
s_waitcnt lgkmcnt(6)
    v_mfma_f32_32x32x16_bf16 v[112:127], v[68:71], v[196:199], v[112:127]
    v_exp_f32 v38, v38
    v_exp_f32 v39, v39
    v_mul_f32 v96, v96, v104
    v_mul_f32 v97, v97, v105
    ds_read_b64_tr_b16 v[68:69], v15 offset:36864
    ds_read_b64_tr_b16 v[70:71], v15 offset:37120
s_waitcnt lgkmcnt(6)
    v_mfma_f32_32x32x16_bf16 v[112:127], v[72:75], v[200:203], v[112:127]
    v_mul_f32 v98, v98, v106
    v_mul_f32 v99, v99, v107
    v_mul_f32 v100, v100, v108
    v_mul_f32 v101, v101, v109
    s_add_u32 s83, s83, 48128
    buffer_load_dwordx4 v9, s[40:43], s83 offen offset:1024 lds
    ds_read_b64_tr_b16 v[72:73], v16 offset:36864
    ds_read_b64_tr_b16 v[74:75], v16 offset:37120
s_waitcnt lgkmcnt(6)
    v_mfma_f32_32x32x16_bf16 v[112:127], v[76:79], v[204:207], v[112:127]
    v_mul_f32 v102, v102, v110
    v_mul_f32 v103, v103, v111
    v_add_f32 v32, 1.0, v32
    v_add_f32 v33, 1.0, v33
    ds_read_b64_tr_b16 v[76:77], v17 offset:36864
    ds_read_b64_tr_b16 v[78:79], v17 offset:37120
s_waitcnt lgkmcnt(6)
    v_mfma_f32_32x32x16_bf16 v[112:127], v[64:67], v[208:211], v[112:127]
    v_add_f32 v34, 1.0, v34
    v_add_f32 v35, 1.0, v35
    v_add_f32 v36, 1.0, v36
    v_add_f32 v37, 1.0, v37
    v_mfma_f32_16x16x32_bf16 v[24:27], v[64:67], v[28:31], v[24:27]
    v_add_f32 v38, 1.0, v38
    v_add_f32 v39, 1.0, v39
    v_rcp_f32 v32, v32
    v_rcp_f32 v33, v33
    ds_read_b64_tr_b16 v[64:65], v14 offset:40960
    ds_read_b64_tr_b16 v[66:67], v14 offset:41216
s_waitcnt lgkmcnt(6)
    v_mfma_f32_32x32x16_bf16 v[112:127], v[68:71], v[212:215], v[112:127]
    v_rcp_f32 v34, v34
    v_rcp_f32 v35, v35
    v_rcp_f32 v36, v36
    v_rcp_f32 v37, v37
    ds_read_b64_tr_b16 v[68:69], v15 offset:40960
    ds_read_b64_tr_b16 v[70:71], v15 offset:41216
s_waitcnt lgkmcnt(6)
    v_mfma_f32_32x32x16_bf16 v[112:127], v[72:75], v[216:219], v[112:127]
    v_rcp_f32 v38, v38
    v_rcp_f32 v39, v39
    v_mul_f32 v96, v96, v32
    v_mul_f32 v97, v97, v33
    s_add_u32 s83, s83, 48128
    buffer_load_dwordx4 v9, s[40:43], s83 offen offset:2048 lds
    ds_read_b64_tr_b16 v[72:73], v16 offset:40960
    ds_read_b64_tr_b16 v[74:75], v16 offset:41216
s_waitcnt lgkmcnt(6)
    v_mfma_f32_32x32x16_bf16 v[112:127], v[76:79], v[220:223], v[112:127]
    v_mul_f32 v98, v98, v34
    v_mul_f32 v99, v99, v35
    v_mul_f32 v100, v100, v36
    v_mul_f32 v101, v101, v37
    ds_read_b64_tr_b16 v[76:77], v17 offset:40960
    ds_read_b64_tr_b16 v[78:79], v17 offset:41216
s_waitcnt lgkmcnt(6)
    v_mfma_f32_32x32x16_bf16 v[112:127], v[64:67], v[224:227], v[112:127]
    v_mul_f32 v102, v102, v38
    v_mul_f32 v103, v103, v39
    v_cvt_pk_bf16_f32 v40, v96, v97
    v_cvt_pk_bf16_f32 v41, v98, v99
    v_mfma_f32_16x16x32_bf16 v[24:27], v[64:67], v[28:31], v[24:27]
    v_cvt_pk_bf16_f32 v42, v100, v101
    v_cvt_pk_bf16_f32 v43, v102, v103
    s_lshl_b32 s76, s62, 11
    s_add_u32 s76, s76, s81
    ds_read_b64_tr_b16 v[64:65], v14 offset:45056
    ds_read_b64_tr_b16 v[66:67], v14 offset:45312
s_waitcnt lgkmcnt(6)
    v_mfma_f32_32x32x16_bf16 v[112:127], v[68:71], v[228:231], v[112:127]
    buffer_store_dwordx4 v[40:43], v1, s[44:47], s76 offen offset:0 sc1
    ds_read_b64_tr_b16 v[68:69], v15 offset:45056
    ds_read_b64_tr_b16 v[70:71], v15 offset:45312
s_waitcnt lgkmcnt(6)
    v_mfma_f32_32x32x16_bf16 v[112:127], v[72:75], v[232:235], v[112:127]
    s_add_u32 s83, s83, 48128
    buffer_load_dwordx4 v9, s[40:43], s83 offen offset:3072 lds
    ds_read_b64_tr_b16 v[72:73], v16 offset:45056
    ds_read_b64_tr_b16 v[74:75], v16 offset:45312
s_waitcnt lgkmcnt(6)
    v_mfma_f32_32x32x16_bf16 v[112:127], v[76:79], v[236:239], v[112:127]
    ds_read_b64_tr_b16 v[76:77], v17 offset:45056
    ds_read_b64_tr_b16 v[78:79], v17 offset:45312
s_waitcnt lgkmcnt(6)
    v_mfma_f32_32x32x16_bf16 v[112:127], v[64:67], v[240:243], v[112:127]
    v_mfma_f32_16x16x32_bf16 v[24:27], v[64:67], v[28:31], v[24:27]
    s_mov_b64 exec, s[26:27]
s_nop 6
    ds_write_b128 v19, v[24:27] offset:2048
    s_mov_b64 exec, -1
s_waitcnt vmcnt(10)
s_waitcnt lgkmcnt(0)
    s_barrier
    v_xor_b32 v14, 0x10000, v14
    v_xor_b32 v15, 0x10000, v15
    v_xor_b32 v16, 0x10000, v16
    v_xor_b32 v17, 0x10000, v17
    ds_read_b64_tr_b16 v[64:65], v14 offset:0
    ds_read_b64_tr_b16 v[66:67], v14 offset:256
    v_mfma_f32_32x32x16_bf16 v[112:127], v[68:71], v[244:247], v[112:127]
    ds_read_b64_tr_b16 v[68:69], v15 offset:0
    ds_read_b64_tr_b16 v[70:71], v15 offset:256
    v_mfma_f32_32x32x16_bf16 v[112:127], v[72:75], v[248:251], v[112:127]
    ds_read_b64_tr_b16 v[72:73], v16 offset:0
    ds_read_b64_tr_b16 v[74:75], v16 offset:256
    v_mfma_f32_32x32x16_bf16 v[112:127], v[76:79], v[252:255], v[112:127]
    ds_read_b64_tr_b16 v[76:77], v17 offset:0
    ds_read_b64_tr_b16 v[78:79], v17 offset:256
s_waitcnt lgkmcnt(6)
    v_mfma_f32_32x32x16_bf16 v[80:95], v[64:67], v[128:131], 0
    v_mfma_f32_16x16x32_bf16 v[24:27], v[64:67], v[28:31], 0
    s_mov_b32 s32, s16
    s_and_b32 s33, s17, 0xffff
    s_mov_b32 s34, 524288
    s_mov_b32 s35, 0x00020000
    s_lshr_b32 s76, s2, 3
    s_mul_i32 s76, s76, 59
    s_add_u32 s76, s76, s56
    ds_read_b64_tr_b16 v[64:65], v14 offset:4096
    ds_read_b64_tr_b16 v[66:67], v14 offset:4352
s_waitcnt lgkmcnt(6)
    v_mfma_f32_32x32x16_bf16 v[80:95], v[68:71], v[132:135], v[80:95]
    s_lshl_b32 s80, s76, 10
    s_sub_u32 s76, s80, 1409024
    s_cmp_lt_u32 s80, 1409024
    s_cbranch_scc0 K1_PF0_B
    buffer_load_dwordx4 v[10:13], v1, s[52:55], s80 offen
    s_branch K1_PF0_J
    K1_PF0_B:
    buffer_load_dwordx4 v[10:13], v1, s[32:35], s76 offen
    K1_PF0_J:
    s_add_u32 s80, s80, 8192
    s_sub_u32 s76, s80, 1409024
    s_cmp_lt_u32 s80, 1409024
    s_cbranch_scc0 K1_PF1_B
    buffer_load_dwordx4 v[10:13], v1, s[52:55], s80 offen
    s_branch K1_PF1_J
    K1_PF1_B:
    buffer_load_dwordx4 v[10:13], v1, s[32:35], s76 offen
    K1_PF1_J:
    s_add_u32 s80, s80, 8192
    s_sub_u32 s76, s80, 1409024
    s_cmp_lt_u32 s80, 1409024
    s_cbranch_scc0 K1_PF2_B
    buffer_load_dwordx4 v[10:13], v1, s[52:55], s80 offen
    s_branch K1_PF2_J
    K1_PF2_B:
    buffer_load_dwordx4 v[10:13], v1, s[32:35], s76 offen
    K1_PF2_J:
    s_add_u32 s80, s80, 8192
    s_sub_u32 s76, s80, 1409024
    s_cmp_lt_u32 s80, 1409024
    s_cbranch_scc0 K1_PF3_B
    buffer_load_dwordx4 v[10:13], v1, s[52:55], s80 offen
    s_branch K1_PF3_J
    K1_PF3_B:
    buffer_load_dwordx4 v[10:13], v1, s[32:35], s76 offen
    K1_PF3_J:
    s_add_u32 s80, s80, 8192
    s_sub_u32 s76, s80, 1409024
    s_cmp_lt_u32 s80, 1409024
    s_cbranch_scc0 K1_PF4_B
    buffer_load_dwordx4 v[10:13], v1, s[52:55], s80 offen
    s_branch K1_PF4_J
    K1_PF4_B:
    buffer_load_dwordx4 v[10:13], v1, s[32:35], s76 offen
    K1_PF4_J:
    s_add_u32 s80, s80, 8192
    s_sub_u32 s76, s80, 1409024
    s_cmp_lt_u32 s80, 1409024
    s_cbranch_scc0 K1_PF5_B
    buffer_load_dwordx4 v[10:13], v1, s[52:55], s80 offen
    s_branch K1_PF5_J
    K1_PF5_B:
    buffer_load_dwordx4 v[10:13], v1, s[32:35], s76 offen
    K1_PF5_J:
    s_add_u32 s80, s80, 8192
    ds_read_b64_tr_b16 v[68:69], v15 offset:4096
    ds_read_b64_tr_b16 v[70:71], v15 offset:4352
s_waitcnt lgkmcnt(6)
    v_mfma_f32_32x32x16_bf16 v[80:95], v[72:75], v[136:139], v[80:95]
    s_sub_u32 s76, s80, 1409024
    s_cmp_lt_u32 s80, 1409024
    s_cbranch_scc0 K1_PF6_B
    buffer_load_dwordx4 v[10:13], v1, s[52:55], s80 offen
    s_branch K1_PF6_J
    K1_PF6_B:
    buffer_load_dwordx4 v[10:13], v1, s[32:35], s76 offen
    K1_PF6_J:
    s_add_u32 s80, s80, 8192
    s_cmp_ge_u32 s56, 3
    s_cselect_b32 s80, 0x7000000, s80
    s_sub_u32 s76, s80, 1409024
    s_cmp_lt_u32 s80, 1409024
    s_cbranch_scc0 K1_PF7_B
    buffer_load_dwordx4 v[10:13], v1, s[52:55], s80 offen
    s_branch K1_PF7_J
    K1_PF7_B:
    buffer_load_dwordx4 v[10:13], v1, s[32:35], s76 offen
    K1_PF7_J:
    s_add_u32 s80, s80, 8192
    v_and_b32 v40, 31, v0
    s_lshl_b32 s78, s58, 9
    s_add_u32 s78, s78, 157696
    v_lshl_add_u32 v41, v40, 2, s78
    ds_read2_b32 v[32:33], v41 offset0:0 offset1:32
    ds_read_b64_tr_b16 v[72:73], v16 offset:4096
    ds_read_b64_tr_b16 v[74:75], v16 offset:4352
s_waitcnt lgkmcnt(7)
    v_mfma_f32_32x32x16_bf16 v[80:95], v[76:79], v[140:143], v[80:95]
    ds_read2_b32 v[34:35], v41 offset0:64 offset1:96
    s_lshl_b32 s78, s56, 7
    s_add_u32 s78, s78, 160768
    v_lshl_add_u32 v40, v40, 2, s78
    ds_read_b64_tr_b16 v[76:77], v17 offset:4096
    ds_read_b64_tr_b16 v[78:79], v17 offset:4352
s_waitcnt lgkmcnt(8)
    v_mfma_f32_32x32x16_bf16 v[80:95], v[64:67], v[144:147], v[80:95]
    v_mfma_f32_16x16x32_bf16 v[24:27], v[64:67], v[28:31], v[24:27]
s_waitcnt lgkmcnt(5)
    v_add_f32 v32, v32, v33
s_waitcnt lgkmcnt(2)
    v_add_f32 v34, v34, v35
    v_add_f32 v32, v32, v34
    ds_write_b32 v40, v32
    ds_read_b128 v[32:35], v18 offset:0
    ds_read_b128 v[36:39], v18 offset:32
    ds_read_b128 v[40:43], v18 offset:64
    ds_read_b64_tr_b16 v[64:65], v14 offset:8192
    ds_read_b64_tr_b16 v[66:67], v14 offset:8448
    v_mfma_f32_32x32x16_bf16 v[80:95], v[68:71], v[148:151], v[80:95]
    ds_read_b128 v[44:47], v18 offset:96
    ds_read_b64_tr_b16 v[68:69], v15 offset:8192
    ds_read_b64_tr_b16 v[70:71], v15 offset:8448
    v_mfma_f32_32x32x16_bf16 v[80:95], v[72:75], v[152:155], v[80:95]
    ds_read_b64_tr_b16 v[72:73], v16 offset:8192
    ds_read_b64_tr_b16 v[74:75], v16 offset:8448
s_waitcnt lgkmcnt(11)
    v_mfma_f32_32x32x16_bf16 v[80:95], v[76:79], v[156:159], v[80:95]
s_waitcnt lgkmcnt(9)
    v_mul_f32 v32, v32, v3
    v_fma_f32 v112, v112, v2, v32
    v_mul_f32 v33, v33, v3
    v_fma_f32 v113, v113, v2, v33
    v_mul_f32 v34, v34, v3
    v_fma_f32 v114, v114, v2, v34
    v_mul_f32 v35, v35, v3
    ds_read_b64_tr_b16 v[76:77], v17 offset:8192
    ds_read_b64_tr_b16 v[78:79], v17 offset:8448
s_waitcnt lgkmcnt(7)
    v_mfma_f32_32x32x16_bf16 v[80:95], v[64:67], v[160:163], v[80:95]
    v_fma_f32 v115, v115, v2, v35
    v_mul_f32 v36, v36, v3
    v_fma_f32 v116, v116, v2, v36
    v_mul_f32 v37, v37, v3
    v_fma_f32 v117, v117, v2, v37
    v_mul_f32 v38, v38, v3
    v_fma_f32 v118, v118, v2, v38
    v_mfma_f32_16x16x32_bf16 v[24:27], v[64:67], v[28:31], v[24:27]
    v_mul_f32 v39, v39, v3
    v_fma_f32 v119, v119, v2, v39
    v_mul_f32 v40, v40, v3
    v_fma_f32 v120, v120, v2, v40
    v_mul_f32 v41, v41, v3
    v_fma_f32 v121, v121, v2, v41
    v_mul_f32 v42, v42, v3
    ds_read_b64_tr_b16 v[64:65], v14 offset:12288
    ds_read_b64_tr_b16 v[66:67], v14 offset:12544
s_waitcnt lgkmcnt(6)
    v_mfma_f32_32x32x16_bf16 v[80:95], v[68:71], v[164:167], v[80:95]
    v_fma_f32 v122, v122, v2, v42
    v_mul_f32 v43, v43, v3
    v_fma_f32 v123, v123, v2, v43
    v_mul_f32 v44, v44, v3
    v_fma_f32 v124, v124, v2, v44
    v_mul_f32 v45, v45, v3
    v_fma_f32 v125, v125, v2, v45
    ds_read_b64_tr_b16 v[68:69], v15 offset:12288
    ds_read_b64_tr_b16 v[70:71], v15 offset:12544
s_waitcnt lgkmcnt(6)
    v_mfma_f32_32x32x16_bf16 v[80:95], v[72:75], v[168:171], v[80:95]
    v_mul_f32 v46, v46, v3
    v_fma_f32 v126, v126, v2, v46
    v_mul_f32 v47, v47, v3
    v_fma_f32 v127, v127, v2, v47
    v_mul_f32 v32, v112, v112
    v_mul_f32 v33, v113, v113
    v_mul_f32 v34, v114, v114
    ds_read_b64_tr_b16 v[72:73], v16 offset:12288
    ds_read_b64_tr_b16 v[74:75], v16 offset:12544
s_waitcnt lgkmcnt(6)
    v_mfma_f32_32x32x16_bf16 v[80:95], v[76:79], v[172:175], v[80:95]
    v_mul_f32 v35, v115, v115
    v_mul_f32 v36, v116, v116
    v_mul_f32 v37, v117, v117
    v_mul_f32 v38, v118, v118
    v_mul_f32 v39, v119, v119
    v_fmaak_f32 v32, v32, v4, 0xc0135761
    v_fmaak_f32 v33, v33, v4, 0xc0135761
    ds_read_b64_tr_b16 v[76:77], v17 offset:12288
    ds_read_b64_tr_b16 v[78:79], v17 offset:12544
s_waitcnt lgkmcnt(6)
    v_mfma_f32_32x32x16_bf16 v[80:95], v[64:67], v[176:179], v[80:95]
    v_mfma_f32_16x16x32_bf16 v[24:27], v[64:67], v[28:31], v[24:27]
s_waitcnt vmcnt(14)
s_waitcnt lgkmcnt(0)
    s_barrier
    ds_read_b64_tr_b16 v[64:65], v14 offset:32768
    ds_read_b64_tr_b16 v[66:67], v14 offset:33024
    v_mfma_f32_32x32x16_bf16 v[80:95], v[68:71], v[180:183], v[80:95]
    v_fmaak_f32 v34, v34, v4, 0xc0135761
    v_fmaak_f32 v35, v35, v4, 0xc0135761
    v_fmaak_f32 v36, v36, v4, 0xc0135761
    ds_read_b64_tr_b16 v[68:69], v15 offset:32768
    ds_read_b64_tr_b16 v[70:71], v15 offset:33024
    v_mfma_f32_32x32x16_bf16 v[80:95], v[72:75], v[184:187], v[80:95]
    v_fmaak_f32 v37, v37, v4, 0xc0135761
    v_fmaak_f32 v38, v38, v4, 0xc0135761
    v_fmaak_f32 v39, v39, v4, 0xc0135761
    ds_read_b64_tr_b16 v[72:73], v16 offset:32768
    ds_read_b64_tr_b16 v[74:75], v16 offset:33024
    v_mfma_f32_32x32x16_bf16 v[80:95], v[76:79], v[188:191], v[80:95]
    v_mul_f32 v32, v32, v112
    v_mul_f32 v33, v33, v113
    v_mul_f32 v34, v34, v114
    ds_read_b64_tr_b16 v[76:77], v17 offset:32768
    ds_read_b64_tr_b16 v[78:79], v17 offset:33024
s_waitcnt lgkmcnt(6)
    v_mfma_f32_32x32x16_bf16 v[80:95], v[64:67], v[192:195], v[80:95]
    v_mul_f32 v35, v35, v115
    v_mul_f32 v36, v36, v116
    v_mul_f32 v37, v37, v117
    v_mfma_f32_16x16x32_bf16 v[24:27], v[64:67], v[28:31], v[24:27]
    v_mul_f32 v38, v38, v118
    v_mul_f32 v39, v39, v119
    v_exp_f32 v32, v32
    ds_read_b64_tr_b16 v[64:65], v14 offset:36864
    ds_read_b64_tr_b16 v[66:67], v14 offset:37120
s_waitcnt lgkmcnt(6)
    v_mfma_f32_32x32x16_bf16 v[80:95], v[68:71], v[196:199], v[80:95]
    v_exp_f32 v33, v33
    v_exp_f32 v34, v34
    v_exp_f32 v35, v35
    ds_read_b64_tr_b16 v[68:69], v15 offset:36864
    ds_read_b64_tr_b16 v[70:71], v15 offset:37120
s_waitcnt lgkmcnt(6)
    v_mfma_f32_32x32x16_bf16 v[80:95], v[72:75], v[200:203], v[80:95]
    v_exp_f32 v36, v36
    v_exp_f32 v37, v37
    v_exp_f32 v38, v38
    ds_read_b64_tr_b16 v[72:73], v16 offset:36864
    ds_read_b64_tr_b16 v[74:75], v16 offset:37120
s_waitcnt lgkmcnt(6)
    v_mfma_f32_32x32x16_bf16 v[80:95], v[76:79], v[204:207], v[80:95]
    v_exp_f32 v39, v39
    v_mul_f32 v112, v112, v120
    v_mul_f32 v113, v113, v121
    ds_read_b64_tr_b16 v[76:77], v17 offset:36864
    ds_read_b64_tr_b16 v[78:79], v17 offset:37120
s_waitcnt lgkmcnt(6)
    v_mfma_f32_32x32x16_bf16 v[80:95], v[64:67], v[208:211], v[80:95]
    v_mul_f32 v114, v114, v122
    v_mul_f32 v115, v115, v123
    v_mul_f32 v116, v116, v124
    v_mfma_f32_16x16x32_bf16 v[24:27], v[64:67], v[28:31], v[24:27]
    v_mul_f32 v117, v117, v125
    v_mul_f32 v118, v118, v126
    v_mul_f32 v119, v119, v127
    ds_read_b64_tr_b16 v[64:65], v14 offset:40960
    ds_read_b64_tr_b16 v[66:67], v14 offset:41216
s_waitcnt lgkmcnt(6)
    v_mfma_f32_32x32x16_bf16 v[80:95], v[68:71], v[212:215], v[80:95]
    v_add_f32 v32, 1.0, v32
    v_add_f32 v33, 1.0, v33
    v_add_f32 v34, 1.0, v34
    ds_read_b64_tr_b16 v[68:69], v15 offset:40960
    ds_read_b64_tr_b16 v[70:71], v15 offset:41216
s_waitcnt lgkmcnt(6)
    v_mfma_f32_32x32x16_bf16 v[80:95], v[72:75], v[216:219], v[80:95]
    v_add_f32 v35, 1.0, v35
    v_add_f32 v36, 1.0, v36
    v_add_f32 v37, 1.0, v37
    ds_read_b64_tr_b16 v[72:73], v16 offset:40960
    ds_read_b64_tr_b16 v[74:75], v16 offset:41216
s_waitcnt lgkmcnt(6)
    v_mfma_f32_32x32x16_bf16 v[80:95], v[76:79], v[220:223], v[80:95]
    v_add_f32 v38, 1.0, v38
    v_add_f32 v39, 1.0, v39
    v_rcp_f32 v32, v32
    ds_read_b64_tr_b16 v[76:77], v17 offset:40960
    ds_read_b64_tr_b16 v[78:79], v17 offset:41216
s_waitcnt lgkmcnt(6)
    v_mfma_f32_32x32x16_bf16 v[80:95], v[64:67], v[224:227], v[80:95]
    v_rcp_f32 v33, v33
    v_rcp_f32 v34, v34
    v_rcp_f32 v35, v35
    v_mfma_f32_16x16x32_bf16 v[24:27], v[64:67], v[28:31], v[24:27]
    v_rcp_f32 v36, v36
    v_rcp_f32 v37, v37
    v_rcp_f32 v38, v38
    ds_read_b64_tr_b16 v[64:65], v14 offset:45056
    ds_read_b64_tr_b16 v[66:67], v14 offset:45312
s_waitcnt lgkmcnt(6)
    v_mfma_f32_32x32x16_bf16 v[80:95], v[68:71], v[228:231], v[80:95]
    v_rcp_f32 v39, v39
    v_mul_f32 v112, v112, v32
    v_mul_f32 v113, v113, v33
    ds_read_b64_tr_b16 v[68:69], v15 offset:45056
    ds_read_b64_tr_b16 v[70:71], v15 offset:45312
s_waitcnt lgkmcnt(6)
    v_mfma_f32_32x32x16_bf16 v[80:95], v[72:75], v[232:235], v[80:95]
    v_mul_f32 v114, v114, v34
    v_mul_f32 v115, v115, v35
    v_mul_f32 v116, v116, v36
    ds_read_b64_tr_b16 v[72:73], v16 offset:45056
    ds_read_b64_tr_b16 v[74:75], v16 offset:45312
s_waitcnt lgkmcnt(6)
    v_mfma_f32_32x32x16_bf16 v[80:95], v[76:79], v[236:239], v[80:95]
    v_mul_f32 v117, v117, v37
    v_mul_f32 v118, v118, v38
    v_mul_f32 v119, v119, v39
    ds_read_b64_tr_b16 v[76:77], v17 offset:45056
    ds_read_b64_tr_b16 v[78:79], v17 offset:45312
s_waitcnt lgkmcnt(6)
    v_mfma_f32_32x32x16_bf16 v[80:95], v[64:67], v[240:243], v[80:95]
    v_cvt_pk_bf16_f32 v40, v112, v113
    v_cvt_pk_bf16_f32 v41, v114, v115
    v_cvt_pk_bf16_f32 v42, v116, v117
    v_mfma_f32_16x16x32_bf16 v[24:27], v[64:67], v[28:31], v[24:27]
    v_cvt_pk_bf16_f32 v43, v118, v119
    s_lshl_b32 s76, s63, 11
    s_add_u32 s76, s76, s81
s_waitcnt lgkmcnt(4)
    v_mfma_f32_32x32x16_bf16 v[80:95], v[68:71], v[244:247], v[80:95]
    buffer_store_dwordx4 v[40:43], v1, s[44:47], s76 offen offset:0 sc1
s_nop 10
    s_cmp_eq_u32 s56, 7
    s_cbranch_scc1 K1_CNT_I_W7
    buffer_load_dword v20, v1, s[44:47], 0 offen
    s_branch K1_CNT_I_J
    K1_CNT_I_W7:
    s_mov_b64 exec, 1
    s_lshl_b32 s73, s60, 7
    s_add_u32 s73, s73, 8519680
    v_mov_b32 v21, s73
    buffer_load_dword v20, v21, s[44:47], 0 offen sc1
    s_mov_b64 exec, -1
    K1_CNT_I_J:
s_waitcnt lgkmcnt(2)
    v_mfma_f32_32x32x16_bf16 v[80:95], v[72:75], v[248:251], v[80:95]
s_waitcnt lgkmcnt(0)
    v_mfma_f32_32x32x16_bf16 v[80:95], v[76:79], v[252:255], v[80:95]
    s_mov_b64 exec, s[26:27]
    ds_write_b128 v19, v[24:27] offset:3072
    s_mov_b64 exec, -1
s_waitcnt vmcnt(0)
    s_cmp_eq_u32 s56, 7
    s_cbranch_scc0 K1_CNT_OK
    s_mov_b32 s79, 0
    s_mov_b64 exec, 1
    s_branch K1_CNT_CHK
    K1_CNT_POLL:
    s_sleep 8
    buffer_load_dword v20, v21, s[44:47], 0 offen sc1
    s_waitcnt vmcnt(0)
    K1_CNT_CHK:
    s_add_u32 s79, s79, 1
    v_readfirstlane_b32 s77, v20
    s_nop 3
    s_cmp_ge_u32 s77, 16
    s_cbranch_scc1 K1_CNT_DONE
    s_cmp_lt_u32 s79, 20000
    s_cbranch_scc1 K1_CNT_POLL
    K1_CNT_DONE:
    s_mov_b64 exec, -1
K1_CNT_OK:
s_waitcnt lgkmcnt(0)
    s_barrier
    v_bfe_u32 v58, v0, 2, 2
    v_lshrrev_b32 v57, 5, v0
    v_lshl_add_u32 v58, v57, 3, v58
    v_lshlrev_b32 v58, 6, v58
    v_and_b32 v59, 1, v0
    v_bfe_u32 v60, v0, 1, 1
    v_lshl_or_b32 v59, v59, 1, v60
    v_lshl_add_u32 v58, v59, 3, v58
    v_bfe_u32 v59, v0, 4, 1
    v_lshl_add_u32 v58, v59, 5, v58
    s_lshl_b32 s69, s58, 14
    s_add_u32 s69, s69, 0x10000
    s_xor_b32 s68, s82, 0
    s_lshl_b32 s68, s68, 10
    s_add_u32 s68, s68, s69
    v_add_u32 v14, s68, v58
    s_xor_b32 s68, s82, 1
    s_lshl_b32 s68, s68, 10
    s_add_u32 s68, s68, s69
    v_add_u32 v15, s68, v58
    s_xor_b32 s68, s82, 2
    s_lshl_b32 s68, s68, 10
    s_add_u32 s68, s68, s69
    v_add_u32 v16, s68, v58
    s_xor_b32 s68, s82, 3
    s_lshl_b32 s68, s68, 10
    s_add_u32 s68, s68, s69
    v_add_u32 v17, s68, v58
s_nop 1
    s_cmp_eq_u32 s58, 1
    s_cbranch_scc1 K1_Q1
    ds_read_b64_tr_b16 v[64:65], v14 offset:0
    ds_read_b64_tr_b16 v[66:67], v14 offset:256
    ds_read_b64_tr_b16 v[68:69], v15 offset:0
    ds_read_b64_tr_b16 v[70:71], v15 offset:256
    ds_read_b64_tr_b16 v[72:73], v16 offset:0
    ds_read_b64_tr_b16 v[74:75], v16 offset:256
    ds_read_b64_tr_b16 v[76:77], v17 offset:0
    ds_read_b64_tr_b16 v[78:79], v17 offset:256
s_waitcnt lgkmcnt(6)
    v_mfma_f32_32x32x16_bf16 v[96:111], v[64:67], v[128:131], 0
    v_and_b32 v40, 31, v0
    s_lshl_b32 s78, s58, 9
    s_add_u32 s78, s78, 158720
    v_lshl_add_u32 v41, v40, 2, s78
    ds_read2_b32 v[32:33], v41 offset0:0 offset1:32
    ds_read2_b32 v[34:35], v41 offset0:64 offset1:96
    s_lshl_b32 s78, s56, 7
    s_add_u32 s78, s78, 160768
    v_lshl_add_u32 v40, v40, 2, s78
    v_mfma_f32_16x16x32_bf16 v[24:27], v[64:67], v[28:31], 0
    ds_read_b64_tr_b16 v[64:65], v14 offset:4096
    ds_read_b64_tr_b16 v[66:67], v14 offset:4352
s_waitcnt lgkmcnt(8)
    v_mfma_f32_32x32x16_bf16 v[96:111], v[68:71], v[132:135], v[96:111]
s_waitcnt lgkmcnt(3)
    v_add_f32 v32, v32, v33
s_waitcnt lgkmcnt(2)
    v_add_f32 v34, v34, v35
    v_add_f32 v32, v32, v34
    ds_write_b32 v40, v32
    ds_read_b128 v[32:35], v18 offset:0
    ds_read_b128 v[36:39], v18 offset:32
    ds_read_b128 v[40:43], v18 offset:64
    ds_read_b128 v[44:47], v18 offset:96
    ds_read_b64_tr_b16 v[68:69], v15 offset:4096
    ds_read_b64_tr_b16 v[70:71], v15 offset:4352
    v_mfma_f32_32x32x16_bf16 v[96:111], v[72:75], v[136:139], v[96:111]
    ds_read_b64_tr_b16 v[72:73], v16 offset:4096
    ds_read_b64_tr_b16 v[74:75], v16 offset:4352
    v_mfma_f32_32x32x16_bf16 v[96:111], v[76:79], v[140:143], v[96:111]
s_waitcnt lgkmcnt(7)
    v_mul_f32 v32, v32, v3
    v_fma_f32 v80, v80, v2, v32
    v_mul_f32 v33, v33, v3
    v_fma_f32 v81, v81, v2, v33
    v_mul_f32 v34, v34, v3
    v_fma_f32 v82, v82, v2, v34
    v_mul_f32 v35, v35, v3
    v_fma_f32 v83, v83, v2, v35
s_waitcnt lgkmcnt(6)
    v_mul_f32 v36, v36, v3
    v_fma_f32 v84, v84, v2, v36
    v_mul_f32 v37, v37, v3
    v_fma_f32 v85, v85, v2, v37
    v_mul_f32 v38, v38, v3
    v_fma_f32 v86, v86, v2, v38
    ds_read_b64_tr_b16 v[76:77], v17 offset:4096
    ds_read_b64_tr_b16 v[78:79], v17 offset:4352
    v_mfma_f32_32x32x16_bf16 v[96:111], v[64:67], v[144:147], v[96:111]
    v_mul_f32 v39, v39, v3
    v_fma_f32 v87, v87, v2, v39
s_waitcnt lgkmcnt(7)
    v_mul_f32 v40, v40, v3
    v_fma_f32 v88, v88, v2, v40
    v_mul_f32 v41, v41, v3
    v_fma_f32 v89, v89, v2, v41
    v_mul_f32 v42, v42, v3
    v_fma_f32 v90, v90, v2, v42
    v_mul_f32 v43, v43, v3
    v_fma_f32 v91, v91, v2, v43
s_waitcnt lgkmcnt(6)
    v_mul_f32 v44, v44, v3
    v_fma_f32 v92, v92, v2, v44
    v_mul_f32 v45, v45, v3
    v_fma_f32 v93, v93, v2, v45
    v_mfma_f32_16x16x32_bf16 v[24:27], v[64:67], v[28:31], v[24:27]
    v_mul_f32 v46, v46, v3
    v_fma_f32 v94, v94, v2, v46
    v_mul_f32 v47, v47, v3
    v_fma_f32 v95, v95, v2, v47
    v_mul_f32 v32, v80, v80
    v_mul_f32 v33, v81, v81
    v_mul_f32 v34, v82, v82
    v_mul_f32 v35, v83, v83
    v_mul_f32 v36, v84, v84
    v_mul_f32 v37, v85, v85
    v_mul_f32 v38, v86, v86
    v_mul_f32 v39, v87, v87
    v_fmaak_f32 v32, v32, v4, 0xc0135761
    v_fmaak_f32 v33, v33, v4, 0xc0135761
    ds_read_b64_tr_b16 v[64:65], v14 offset:8192
    ds_read_b64_tr_b16 v[66:67], v14 offset:8448
s_waitcnt lgkmcnt(6)
    v_mfma_f32_32x32x16_bf16 v[96:111], v[68:71], v[148:151], v[96:111]
    v_fmaak_f32 v34, v34, v4, 0xc0135761
    v_fmaak_f32 v35, v35, v4, 0xc0135761
    v_fmaak_f32 v36, v36, v4, 0xc0135761
    v_fmaak_f32 v37, v37, v4, 0xc0135761
    v_fmaak_f32 v38, v38, v4, 0xc0135761
    v_fmaak_f32 v39, v39, v4, 0xc0135761
    v_mul_f32 v32, v32, v80
    v_mul_f32 v33, v33, v81
    v_mul_f32 v34, v34, v82
    v_mul_f32 v35, v35, v83
    v_mul_f32 v36, v36, v84
    v_mul_f32 v37, v37, v85
    v_mul_f32 v38, v38, v86
    v_mul_f32 v39, v39, v87
    ds_read_b64_tr_b16 v[68:69], v15 offset:8192
    ds_read_b64_tr_b16 v[70:71], v15 offset:8448
s_waitcnt lgkmcnt(6)
    v_mfma_f32_32x32x16_bf16 v[96:111], v[72:75], v[152:155], v[96:111]
    v_exp_f32 v32, v32
    v_exp_f32 v33, v33
    v_exp_f32 v34, v34
    v_exp_f32 v35, v35
    v_exp_f32 v36, v36
    v_exp_f32 v37, v37
    v_exp_f32 v38, v38
    v_exp_f32 v39, v39
    v_mul_f32 v80, v80, v88
    v_mul_f32 v81, v81, v89
    v_mul_f32 v82, v82, v90
    v_mul_f32 v83, v83, v91
    v_mul_f32 v84, v84, v92
    v_mul_f32 v85, v85, v93
    ds_read_b64_tr_b16 v[72:73], v16 offset:8192
    ds_read_b64_tr_b16 v[74:75], v16 offset:8448
s_waitcnt lgkmcnt(6)
    v_mfma_f32_32x32x16_bf16 v[96:111], v[76:79], v[156:159], v[96:111]
    v_mul_f32 v86, v86, v94
    v_mul_f32 v87, v87, v95
    v_add_f32 v32, 1.0, v32
    v_add_f32 v33, 1.0, v33
    v_add_f32 v34, 1.0, v34
    v_add_f32 v35, 1.0, v35
    v_add_f32 v36, 1.0, v36
    v_add_f32 v37, 1.0, v37
    v_add_f32 v38, 1.0, v38
    v_add_f32 v39, 1.0, v39
    v_rcp_f32 v32, v32
    v_rcp_f32 v33, v33
    v_rcp_f32 v34, v34
    v_rcp_f32 v35, v35
    ds_read_b64_tr_b16 v[76:77], v17 offset:8192
    ds_read_b64_tr_b16 v[78:79], v17 offset:8448
s_waitcnt lgkmcnt(6)
    v_mfma_f32_32x32x16_bf16 v[96:111], v[64:67], v[160:163], v[96:111]
    v_rcp_f32 v36, v36
    v_rcp_f32 v37, v37
    v_rcp_f32 v38, v38
    v_rcp_f32 v39, v39
    v_mul_f32 v80, v80, v32
    v_mul_f32 v81, v81, v33
    v_mul_f32 v82, v82, v34
    v_mul_f32 v83, v83, v35
    v_mul_f32 v84, v84, v36
    v_mul_f32 v85, v85, v37
    v_mul_f32 v86, v86, v38
    v_mul_f32 v87, v87, v39
    v_cvt_pk_bf16_f32 v40, v80, v81
    v_cvt_pk_bf16_f32 v41, v82, v83
    v_mfma_f32_16x16x32_bf16 v[24:27], v[64:67], v[28:31], v[24:27]
    v_cvt_pk_bf16_f32 v42, v84, v85
    v_cvt_pk_bf16_f32 v43, v86, v87
    s_lshl_b32 s76, s64, 11
    s_add_u32 s76, s76, s81
    buffer_store_dwordx4 v[40:43], v1, s[44:47], s76 offen offset:0 sc1
    ds_read_b64_tr_b16 v[64:65], v14 offset:12288
    ds_read_b64_tr_b16 v[66:67], v14 offset:12544
s_waitcnt lgkmcnt(6)
    v_mfma_f32_32x32x16_bf16 v[96:111], v[68:71], v[164:167], v[96:111]
    ds_read_b64_tr_b16 v[68:69], v15 offset:12288
    ds_read_b64_tr_b16 v[70:71], v15 offset:12544
s_waitcnt lgkmcnt(6)
    v_mfma_f32_32x32x16_bf16 v[96:111], v[72:75], v[168:171], v[96:111]
    ds_read_b64_tr_b16 v[72:73], v16 offset:12288
    ds_read_b64_tr_b16 v[74:75], v16 offset:12544
s_waitcnt lgkmcnt(6)
    v_mfma_f32_32x32x16_bf16 v[96:111], v[76:79], v[172:175], v[96:111]
    ds_read_b64_tr_b16 v[76:77], v17 offset:12288
    ds_read_b64_tr_b16 v[78:79], v17 offset:12544
s_waitcnt lgkmcnt(6)
    v_mfma_f32_32x32x16_bf16 v[96:111], v[64:67], v[176:179], v[96:111]
    v_mfma_f32_16x16x32_bf16 v[24:27], v[64:67], v[28:31], v[24:27]
s_waitcnt lgkmcnt(4)
    v_mfma_f32_32x32x16_bf16 v[96:111], v[68:71], v[180:183], v[96:111]
s_waitcnt lgkmcnt(2)
    v_mfma_f32_32x32x16_bf16 v[96:111], v[72:75], v[184:187], v[96:111]
s_waitcnt lgkmcnt(0)
    v_mfma_f32_32x32x16_bf16 v[96:111], v[76:79], v[188:191], v[96:111]
    s_mov_b64 exec, s[26:27]
s_nop 0
    ds_write_b128 v19, v[24:27] offset:4096
    s_mov_b64 exec, -1
    s_lshl_b32 s68, s57, 12
    s_add_u32 s68, s68, 131072
    v_add_u32 v53, s68, v1
s_nop 4
    ds_write_b128 v53, v[96:99] offset:0
    ds_write_b128 v53, v[100:103] offset:1024
    ds_write_b128 v53, v[104:107] offset:2048
    ds_write_b128 v53, v[108:111] offset:3072
    v_mov_b32 v21, 162048
    v_mov_b32 v20, 0
    ds_write_b32 v21, v20
    ds_write_b32 v21, v20 offset:4
s_waitcnt vmcnt(0)
s_waitcnt lgkmcnt(0)
    s_barrier
    s_branch K2_ENTRY
K1_Q1:
    v_and_b32 v56, 15, v0
    v_lshlrev_b32 v56, 1, v56
    v_lshrrev_b32 v57, 5, v0
    v_lshl_add_u32 v56, v57, 8, v56
    s_lshl_b32 s68, s60, 10
    buffer_load_ushort v128, v56, s[48:51], s68 offen offset:0
    buffer_load_ushort v129, v56, s[48:51], s68 offen offset:32
    buffer_load_ushort v130, v56, s[48:51], s68 offen offset:64
    buffer_load_ushort v131, v56, s[48:51], s68 offen offset:96
    buffer_load_ushort v132, v56, s[48:51], s68 offen offset:128
    buffer_load_ushort v133, v56, s[48:51], s68 offen offset:160
    buffer_load_ushort v134, v56, s[48:51], s68 offen offset:192
    buffer_load_ushort v135, v56, s[48:51], s68 offen offset:224
    buffer_load_ushort v136, v56, s[48:51], s68 offen offset:512
    buffer_load_ushort v137, v56, s[48:51], s68 offen offset:544
    buffer_load_ushort v138, v56, s[48:51], s68 offen offset:576
    buffer_load_ushort v139, v56, s[48:51], s68 offen offset:608
    buffer_load_ushort v140, v56, s[48:51], s68 offen offset:640
    buffer_load_ushort v141, v56, s[48:51], s68 offen offset:672
    buffer_load_ushort v142, v56, s[48:51], s68 offen offset:704
    buffer_load_ushort v143, v56, s[48:51], s68 offen offset:736
    v_and_b32 v58, 3, v0
    v_bfe_u32 v59, v0, 2, 1
    v_bfe_u32 v60, v0, 3, 1
    v_lshl_or_b32 v58, v59, 3, v58
    v_lshl_or_b32 v58, v60, 2, v58
    v_lshlrev_b32 v58, 2, v58
    v_mov_b32 v59, 0x10000
    v_and_b32 v60, 16, v0
    v_cmp_eq_u32 vcc, 0, v60
s_nop 1
    v_cndmask_b32 v58, v59, v58, vcc
    v_lshl_add_u32 v58, v57, 6, v58
    s_lshl_b32 s75, s60, 12
    s_add_u32 s75, s75, 8388608
    ds_read_b64_tr_b16 v[64:65], v14 offset:0
    ds_read_b64_tr_b16 v[66:67], v14 offset:256
    buffer_load_dword v144, v58, s[44:47], s75 offen offset:0 sc1
    buffer_load_dword v145, v58, s[44:47], s75 offen offset:256 sc1
    ds_read_b64_tr_b16 v[68:69], v15 offset:0
    ds_read_b64_tr_b16 v[70:71], v15 offset:256
    buffer_load_dword v146, v58, s[44:47], s75 offen offset:512 sc1
    buffer_load_dword v147, v58, s[44:47], s75 offen offset:768 sc1
    ds_read_b64_tr_b16 v[72:73], v16 offset:0
    ds_read_b64_tr_b16 v[74:75], v16 offset:256
    buffer_load_dword v148, v58, s[44:47], s75 offen offset:128 sc1
    buffer_load_dword v149, v58, s[44:47], s75 offen offset:384 sc1
    ds_read_b64_tr_b16 v[76:77], v17 offset:0
    ds_read_b64_tr_b16 v[78:79], v17 offset:256
    buffer_load_dword v150, v58, s[44:47], s75 offen offset:640 sc1
    buffer_load_dword v151, v58, s[44:47], s75 offen offset:896 sc1
s_waitcnt lgkmcnt(6)
    v_mfma_f32_32x32x16_bf16 v[96:111], v[64:67], v[192:195], 0
    v_and_b32 v40, 31, v0
    s_lshl_b32 s78, s58, 9
    s_add_u32 s78, s78, 158720
    v_lshl_add_u32 v41, v40, 2, s78
    ds_read2_b32 v[32:33], v41 offset0:0 offset1:32
    ds_read2_b32 v[34:35], v41 offset0:64 offset1:96
    s_lshl_b32 s78, s56, 7
    s_add_u32 s78, s78, 160768
    v_lshl_add_u32 v40, v40, 2, s78
    v_mfma_f32_16x16x32_bf16 v[24:27], v[64:67], v[28:31], 0
    ds_read_b64_tr_b16 v[64:65], v14 offset:4096
    ds_read_b64_tr_b16 v[66:67], v14 offset:4352
    buffer_load_dword v152, v58, s[44:47], s75 offen offset:1024 sc1
    buffer_load_dword v153, v58, s[44:47], s75 offen offset:1280 sc1
s_waitcnt lgkmcnt(8)
    v_mfma_f32_32x32x16_bf16 v[96:111], v[68:71], v[196:199], v[96:111]
s_waitcnt lgkmcnt(3)
    v_add_f32 v32, v32, v33
s_waitcnt lgkmcnt(2)
    v_add_f32 v34, v34, v35
    v_add_f32 v32, v32, v34
    ds_write_b32 v40, v32
    ds_read_b128 v[32:35], v18 offset:0
    ds_read_b128 v[36:39], v18 offset:32
    ds_read_b128 v[40:43], v18 offset:64
    ds_read_b128 v[44:47], v18 offset:96
    ds_read_b64_tr_b16 v[68:69], v15 offset:4096
    ds_read_b64_tr_b16 v[70:71], v15 offset:4352
    buffer_load_dword v154, v58, s[44:47], s75 offen offset:1536 sc1
    buffer_load_dword v155, v58, s[44:47], s75 offen offset:1792 sc1
    v_mfma_f32_32x32x16_bf16 v[96:111], v[72:75], v[200:203], v[96:111]
    ds_read_b64_tr_b16 v[72:73], v16 offset:4096
    ds_read_b64_tr_b16 v[74:75], v16 offset:4352
    buffer_load_dword v156, v58, s[44:47], s75 offen offset:1152 sc1
    buffer_load_dword v157, v58, s[44:47], s75 offen offset:1408 sc1
    v_mfma_f32_32x32x16_bf16 v[96:111], v[76:79], v[204:207], v[96:111]
s_waitcnt lgkmcnt(7)
    v_mul_f32 v32, v32, v3
    v_fma_f32 v80, v80, v2, v32
    v_mul_f32 v33, v33, v3
    v_fma_f32 v81, v81, v2, v33
    v_mul_f32 v34, v34, v3
    v_fma_f32 v82, v82, v2, v34
    v_mul_f32 v35, v35, v3
    v_fma_f32 v83, v83, v2, v35
s_waitcnt lgkmcnt(6)
    v_mul_f32 v36, v36, v3
    v_fma_f32 v84, v84, v2, v36
    v_mul_f32 v37, v37, v3
    v_fma_f32 v85, v85, v2, v37
    v_mul_f32 v38, v38, v3
    v_fma_f32 v86, v86, v2, v38
    ds_read_b64_tr_b16 v[76:77], v17 offset:4096
    ds_read_b64_tr_b16 v[78:79], v17 offset:4352
    buffer_load_dword v158, v58, s[44:47], s75 offen offset:1664 sc1
    buffer_load_dword v159, v58, s[44:47], s75 offen offset:1920 sc1
    v_mfma_f32_32x32x16_bf16 v[96:111], v[64:67], v[208:211], v[96:111]
    v_mul_f32 v39, v39, v3
    v_fma_f32 v87, v87, v2, v39
s_waitcnt lgkmcnt(7)
    v_mul_f32 v40, v40, v3
    v_fma_f32 v88, v88, v2, v40
    v_mul_f32 v41, v41, v3
    v_fma_f32 v89, v89, v2, v41
    v_mul_f32 v42, v42, v3
    v_fma_f32 v90, v90, v2, v42
    v_mul_f32 v43, v43, v3
    v_fma_f32 v91, v91, v2, v43
s_waitcnt lgkmcnt(6)
    v_mul_f32 v44, v44, v3
    v_fma_f32 v92, v92, v2, v44
    v_mul_f32 v45, v45, v3
    v_fma_f32 v93, v93, v2, v45
    v_mfma_f32_16x16x32_bf16 v[24:27], v[64:67], v[28:31], v[24:27]
    v_mul_f32 v46, v46, v3
    v_fma_f32 v94, v94, v2, v46
    v_mul_f32 v47, v47, v3
    v_fma_f32 v95, v95, v2, v47
    v_mul_f32 v32, v80, v80
    v_mul_f32 v33, v81, v81
    v_mul_f32 v34, v82, v82
    v_mul_f32 v35, v83, v83
    v_mul_f32 v36, v84, v84
    v_mul_f32 v37, v85, v85
    v_mul_f32 v38, v86, v86
    v_mul_f32 v39, v87, v87
    v_fmaak_f32 v32, v32, v4, 0xc0135761
    v_fmaak_f32 v33, v33, v4, 0xc0135761
    ds_read_b64_tr_b16 v[64:65], v14 offset:8192
    ds_read_b64_tr_b16 v[66:67], v14 offset:8448
    buffer_load_dword v160, v58, s[44:47], s75 offen offset:2048 sc1
    buffer_load_dword v161, v58, s[44:47], s75 offen offset:2304 sc1
s_waitcnt lgkmcnt(6)
    v_mfma_f32_32x32x16_bf16 v[96:111], v[68:71], v[212:215], v[96:111]
    v_fmaak_f32 v34, v34, v4, 0xc0135761
    v_fmaak_f32 v35, v35, v4, 0xc0135761
    v_fmaak_f32 v36, v36, v4, 0xc0135761
    v_fmaak_f32 v37, v37, v4, 0xc0135761
    v_fmaak_f32 v38, v38, v4, 0xc0135761
    v_fmaak_f32 v39, v39, v4, 0xc0135761
    v_mul_f32 v32, v32, v80
    v_mul_f32 v33, v33, v81
    v_mul_f32 v34, v34, v82
    v_mul_f32 v35, v35, v83
    v_mul_f32 v36, v36, v84
    v_mul_f32 v37, v37, v85
    v_mul_f32 v38, v38, v86
    v_mul_f32 v39, v39, v87
    ds_read_b64_tr_b16 v[68:69], v15 offset:8192
    ds_read_b64_tr_b16 v[70:71], v15 offset:8448
    buffer_load_dword v162, v58, s[44:47], s75 offen offset:2560 sc1
    buffer_load_dword v163, v58, s[44:47], s75 offen offset:2816 sc1
s_waitcnt lgkmcnt(6)
    v_mfma_f32_32x32x16_bf16 v[96:111], v[72:75], v[216:219], v[96:111]
    v_exp_f32 v32, v32
    v_exp_f32 v33, v33
    v_exp_f32 v34, v34
    v_exp_f32 v35, v35
    v_exp_f32 v36, v36
    v_exp_f32 v37, v37
    v_exp_f32 v38, v38
    v_exp_f32 v39, v39
    v_mul_f32 v80, v80, v88
    v_mul_f32 v81, v81, v89
    v_mul_f32 v82, v82, v90
    v_mul_f32 v83, v83, v91
    v_mul_f32 v84, v84, v92
    v_mul_f32 v85, v85, v93
    ds_read_b64_tr_b16 v[72:73], v16 offset:8192
    ds_read_b64_tr_b16 v[74:75], v16 offset:8448
    buffer_load_dword v164, v58, s[44:47], s75 offen offset:2176 sc1
    buffer_load_dword v165, v58, s[44:47], s75 offen offset:2432 sc1
s_waitcnt lgkmcnt(6)
    v_mfma_f32_32x32x16_bf16 v[96:111], v[76:79], v[220:223], v[96:111]
    v_mul_f32 v86, v86, v94
    v_mul_f32 v87, v87, v95
    v_add_f32 v32, 1.0, v32
    v_add_f32 v33, 1.0, v33
    v_add_f32 v34, 1.0, v34
    v_add_f32 v35, 1.0, v35
    v_add_f32 v36, 1.0, v36
    v_add_f32 v37, 1.0, v37
    v_add_f32 v38, 1.0, v38
    v_add_f32 v39, 1.0, v39
    v_rcp_f32 v32, v32
    v_rcp_f32 v33, v33
    v_rcp_f32 v34, v34
    v_rcp_f32 v35, v35
    ds_read_b64_tr_b16 v[76:77], v17 offset:8192
    ds_read_b64_tr_b16 v[78:79], v17 offset:8448
    buffer_load_dword v166, v58, s[44:47], s75 offen offset:2688 sc1
    buffer_load_dword v167, v58, s[44:47], s75 offen offset:2944 sc1
s_waitcnt lgkmcnt(6)
    v_mfma_f32_32x32x16_bf16 v[96:111], v[64:67], v[224:227], v[96:111]
    v_rcp_f32 v36, v36
    v_rcp_f32 v37, v37
    v_rcp_f32 v38, v38
    v_rcp_f32 v39, v39
    v_mul_f32 v80, v80, v32
    v_mul_f32 v81, v81, v33
    v_mul_f32 v82, v82, v34
    v_mul_f32 v83, v83, v35
    v_mul_f32 v84, v84, v36
    v_mul_f32 v85, v85, v37
    v_mul_f32 v86, v86, v38
    v_mul_f32 v87, v87, v39
    v_cvt_pk_bf16_f32 v40, v80, v81
    v_cvt_pk_bf16_f32 v41, v82, v83
    v_mfma_f32_16x16x32_bf16 v[24:27], v[64:67], v[28:31], v[24:27]
    v_cvt_pk_bf16_f32 v42, v84, v85
    v_cvt_pk_bf16_f32 v43, v86, v87
    s_lshl_b32 s76, s64, 11
    s_add_u32 s76, s76, s81
    buffer_store_dwordx4 v[40:43], v1, s[44:47], s76 offen offset:0 sc1
    ds_read_b64_tr_b16 v[64:65], v14 offset:12288
    ds_read_b64_tr_b16 v[66:67], v14 offset:12544
    buffer_load_dword v168, v58, s[44:47], s75 offen offset:3072 sc1
    buffer_load_dword v169, v58, s[44:47], s75 offen offset:3328 sc1
s_waitcnt lgkmcnt(6)
    v_mfma_f32_32x32x16_bf16 v[96:111], v[68:71], v[228:231], v[96:111]
    ds_read_b64_tr_b16 v[68:69], v15 offset:12288
    ds_read_b64_tr_b16 v[70:71], v15 offset:12544
    buffer_load_dword v170, v58, s[44:47], s75 offen offset:3584 sc1
    buffer_load_dword v171, v58, s[44:47], s75 offen offset:3840 sc1
s_waitcnt lgkmcnt(6)
    v_mfma_f32_32x32x16_bf16 v[96:111], v[72:75], v[232:235], v[96:111]
    ds_read_b64_tr_b16 v[72:73], v16 offset:12288
    ds_read_b64_tr_b16 v[74:75], v16 offset:12544
    buffer_load_dword v172, v58, s[44:47], s75 offen offset:3200 sc1
    buffer_load_dword v173, v58, s[44:47], s75 offen offset:3456 sc1
s_waitcnt lgkmcnt(6)
    v_mfma_f32_32x32x16_bf16 v[96:111], v[76:79], v[236:239], v[96:111]
    ds_read_b64_tr_b16 v[76:77], v17 offset:12288
    ds_read_b64_tr_b16 v[78:79], v17 offset:12544
    buffer_load_dword v174, v58, s[44:47], s75 offen offset:3712 sc1
    buffer_load_dword v175, v58, s[44:47], s75 offen offset:3968 sc1
s_waitcnt lgkmcnt(6)
    v_mfma_f32_32x32x16_bf16 v[96:111], v[64:67], v[240:243], v[96:111]
    v_mfma_f32_16x16x32_bf16 v[24:27], v[64:67], v[28:31], v[24:27]
s_waitcnt lgkmcnt(4)
    v_mfma_f32_32x32x16_bf16 v[96:111], v[68:71], v[244:247], v[96:111]
s_waitcnt lgkmcnt(2)
    v_mfma_f32_32x32x16_bf16 v[96:111], v[72:75], v[248:251], v[96:111]
s_waitcnt lgkmcnt(0)
    v_mfma_f32_32x32x16_bf16 v[96:111], v[76:79], v[252:255], v[96:111]
    s_mov_b64 exec, s[26:27]
s_nop 0
    ds_write_b128 v19, v[24:27] offset:4096
    s_mov_b64 exec, -1
    v_mov_b32 v21, 162048
    v_mov_b32 v20, 0
    ds_write_b32 v21, v20
    ds_write_b32 v21, v20 offset:4
s_waitcnt vmcnt(8)
s_waitcnt lgkmcnt(0)
    s_barrier
    s_cmp_eq_u32 s56, 7
    s_cbranch_scc0 K1_NOH
    s_lshl_b32 s68, s59, 7
    s_add_u32 s68, s68, 8519684
    v_mov_b32 v54, 0
    v_mov_b32 v55, 1
    s_mov_b64 exec, 1
    buffer_atomic_add v55, v54, s[44:47], s68 offen sc1
    s_mov_b64 exec, -1
K1_NOH:
    s_lshl_b32 s68, s57, 12
    s_add_u32 s68, s68, 131072
    v_add_u32 v53, s68, v1
    ds_read_b128 v[176:179], v53 offset:0
    ds_read_b128 v[180:183], v53 offset:1024
    ds_read_b128 v[184:187], v53 offset:2048
    ds_read_b128 v[188:191], v53 offset:3072
s_waitcnt lgkmcnt(3)
    v_add_f32 v96, v96, v176
    v_add_f32 v97, v97, v177
    v_add_f32 v98, v98, v178
    v_add_f32 v99, v99, v179
s_waitcnt lgkmcnt(2)
    v_add_f32 v100, v100, v180
    v_add_f32 v101, v101, v181
    v_add_f32 v102, v102, v182
    v_add_f32 v103, v103, v183
s_waitcnt lgkmcnt(1)
    v_add_f32 v104, v104, v184
    v_add_f32 v105, v105, v185
    v_add_f32 v106, v106, v186
    v_add_f32 v107, v107, v187
s_waitcnt lgkmcnt(0)
    v_add_f32 v108, v108, v188
    v_add_f32 v109, v109, v189
    v_add_f32 v110, v110, v190
    v_add_f32 v111, v111, v191
    v_and_b32 v40, 31, v0
    v_lshlrev_b32 v41, 2, v40
    v_add_u32 v41, 159744, v41
    ds_read2_b32 v[32:33], v41 offset0:0 offset1:32
    ds_read2_b32 v[34:35], v41 offset0:64 offset1:96
    ds_read2_b32 v[36:37], v41 offset0:128 offset1:160
    ds_read2_b32 v[38:39], v41 offset0:192 offset1:224
    s_lshl_b32 s78, s56, 7
    s_add_u32 s78, s78, 160768
    v_lshl_add_u32 v40, v40, 2, s78
s_waitcnt lgkmcnt(1)
    v_add_f32 v32, v32, v36
    v_add_f32 v33, v33, v37
s_waitcnt lgkmcnt(0)
    v_add_f32 v34, v34, v38
    v_add_f32 v35, v35, v39
    v_add_f32 v32, v32, v33
    v_add_f32 v34, v34, v35
    v_add_f32 v32, v32, v34
    ds_write_b32 v40, v32
    ds_read_b128 v[32:35], v18 offset:0
    ds_read_b128 v[36:39], v18 offset:32
    ds_read_b128 v[40:43], v18 offset:64
    ds_read_b128 v[44:47], v18 offset:96
s_waitcnt lgkmcnt(3)
    v_mul_f32 v32, v32, v3
    v_fma_f32 v96, v96, v2, v32
    v_mul_f32 v33, v33, v3
    v_fma_f32 v97, v97, v2, v33
    v_mul_f32 v34, v34, v3
    v_fma_f32 v98, v98, v2, v34
    v_mul_f32 v35, v35, v3
    v_fma_f32 v99, v99, v2, v35
s_waitcnt lgkmcnt(2)
    v_mul_f32 v36, v36, v3
    v_fma_f32 v100, v100, v2, v36
    v_mul_f32 v37, v37, v3
    v_fma_f32 v101, v101, v2, v37
    v_mul_f32 v38, v38, v3
    v_fma_f32 v102, v102, v2, v38
    v_mul_f32 v39, v39, v3
    v_fma_f32 v103, v103, v2, v39
s_waitcnt lgkmcnt(1)
    v_mul_f32 v40, v40, v3
    v_fma_f32 v104, v104, v2, v40
    v_mul_f32 v41, v41, v3
    v_fma_f32 v105, v105, v2, v41
    v_mul_f32 v42, v42, v3
    v_fma_f32 v106, v106, v2, v42
    v_mul_f32 v43, v43, v3
    v_fma_f32 v107, v107, v2, v43
s_waitcnt lgkmcnt(0)
    v_mul_f32 v44, v44, v3
    v_fma_f32 v108, v108, v2, v44
    v_mul_f32 v45, v45, v3
    v_fma_f32 v109, v109, v2, v45
    v_mul_f32 v46, v46, v3
    v_fma_f32 v110, v110, v2, v46
    v_mul_f32 v47, v47, v3
    v_fma_f32 v111, v111, v2, v47
    v_cvt_pk_bf16_f32 v56, v96, v97
    v_cvt_pk_bf16_f32 v57, v98, v99
    v_cvt_pk_bf16_f32 v58, v100, v101
    v_cvt_pk_bf16_f32 v59, v102, v103
    v_lshl_or_b32 v32, v129, 16, v128
    v_lshl_or_b32 v33, v131, 16, v130
    v_lshl_or_b32 v34, v133, 16, v132
    v_lshl_or_b32 v35, v135, 16, v134
    v_bfe_u32 v52, v0, 4, 1
    v_mul_u32_u24 v52, 0x8000, v52
    v_lshl_or_b32 v52, v52, 16, v52
    v_xor_b32 v32, v32, v52
    v_xor_b32 v33, v33, v52
    v_xor_b32 v34, v34, v52
    v_xor_b32 v35, v35, v52
s_nop 1
    v_mfma_f32_32x32x16_bf16 v[80:95], v[32:35], v[56:59], 0
    v_cvt_pk_bf16_f32 v36, v144, v145
    v_cvt_pk_bf16_f32 v37, v146, v147
    v_cvt_pk_bf16_f32 v38, v148, v149
    v_cvt_pk_bf16_f32 v39, v150, v151
    v_cvt_pk_bf16_f32 v40, v152, v153
    v_cvt_pk_bf16_f32 v41, v154, v155
    v_cvt_pk_bf16_f32 v42, v156, v157
    v_cvt_pk_bf16_f32 v43, v158, v159
    s_lshl_b32 s68, s59, 2
    s_add_u32 s68, s68, s57
    s_lshl_b32 s68, s68, 5
    s_lshl_b32 s69, s60, 1
    s_add_u32 s68, s68, s69
    s_add_u32 s68, s68, 0
    s_lshl_b32 s68, s68, 10
    s_add_u32 s68, s68, 12582912
    v_max3_f32 v52, v80, v81, v82
    v_max3_f32 v53, v83, v84, v85
    v_max3_f32 v52, v52, v86, v87
    v_max_f32 v52, v52, v53
    v_mov_b32 v53, v52
s_nop 1
    v_permlane32_swap_b32 v52, v53
    v_max_f32 v52, v52, v53
    v_mul_f32 v52, 0xbfb8aa3b, v52
    v_mov_b32 v54, 0x3fb8aa3b
    v_fma_f32 v80, v80, v54, v52
    v_fma_f32 v81, v81, v54, v52
    v_fma_f32 v82, v82, v54, v52
    v_fma_f32 v83, v83, v54, v52
    v_fma_f32 v84, v84, v54, v52
    v_fma_f32 v85, v85, v54, v52
    v_fma_f32 v86, v86, v54, v52
    v_fma_f32 v87, v87, v54, v52
    v_exp_f32 v80, v80
    v_exp_f32 v81, v81
    v_exp_f32 v82, v82
    v_exp_f32 v83, v83
    v_exp_f32 v84, v84
    v_exp_f32 v85, v85
    v_exp_f32 v86, v86
    v_exp_f32 v87, v87
    v_add_f32 v54, v80, v81
    v_add_f32 v53, v82, v83
    v_add_f32 v54, v54, v84
    v_add_f32 v53, v53, v85
    v_add_f32 v54, v54, v86
    v_add_f32 v53, v53, v87
    v_add_f32 v54, v54, v53
    v_mov_b32 v53, v54
s_nop 1
    v_permlane32_swap_b32 v54, v53
    v_add_f32 v54, v54, v53
    v_rcp_f32 v54, v54
s_nop 0
    v_mul_f32 v80, v80, v54
    v_mul_f32 v81, v81, v54
    v_mul_f32 v82, v82, v54
    v_mul_f32 v83, v83, v54
    v_mul_f32 v84, v84, v54
    v_mul_f32 v85, v85, v54
    v_mul_f32 v86, v86, v54
    v_mul_f32 v87, v87, v54
    v_cvt_pk_bf16_f32 v44, v80, v81
    v_cvt_pk_bf16_f32 v45, v82, v83
    v_cvt_pk_bf16_f32 v46, v84, v85
    v_cvt_pk_bf16_f32 v47, v86, v87
    v_max3_f32 v52, v88, v89, v90
    v_max3_f32 v53, v91, v92, v93
    v_max3_f32 v52, v52, v94, v95
    v_max_f32 v52, v52, v53
    v_mov_b32 v53, v52
s_nop 1
    v_permlane32_swap_b32 v52, v53
    v_max_f32 v52, v52, v53
    v_mul_f32 v52, 0xbfb8aa3b, v52
    v_mov_b32 v54, 0x3fb8aa3b
    v_fma_f32 v88, v88, v54, v52
    v_fma_f32 v89, v89, v54, v52
    v_fma_f32 v90, v90, v54, v52
    v_fma_f32 v91, v91, v54, v52
    v_fma_f32 v92, v92, v54, v52
    v_fma_f32 v93, v93, v54, v52
    v_fma_f32 v94, v94, v54, v52
    v_fma_f32 v95, v95, v54, v52
    v_exp_f32 v88, v88
    v_exp_f32 v89, v89
    v_exp_f32 v90, v90
    v_exp_f32 v91, v91
    v_exp_f32 v92, v92
    v_exp_f32 v93, v93
    v_exp_f32 v94, v94
    v_exp_f32 v95, v95
    v_add_f32 v54, v88, v89
    v_add_f32 v53, v90, v91
    v_add_f32 v54, v54, v92
    v_add_f32 v53, v53, v93
    v_add_f32 v54, v54, v94
    v_add_f32 v53, v53, v95
    v_add_f32 v54, v54, v53
    v_mov_b32 v53, v54
s_nop 1
    v_permlane32_swap_b32 v54, v53
    v_add_f32 v54, v54, v53
    v_rcp_f32 v54, v54
s_nop 0
    v_mul_f32 v88, v88, v54
    v_mul_f32 v89, v89, v54
    v_mul_f32 v90, v90, v54
    v_mul_f32 v91, v91, v54
    v_mul_f32 v92, v92, v54
    v_mul_f32 v93, v93, v54
    v_mul_f32 v94, v94, v54
    v_mul_f32 v95, v95, v54
    v_cvt_pk_bf16_f32 v48, v88, v89
    v_cvt_pk_bf16_f32 v49, v90, v91
    v_cvt_pk_bf16_f32 v50, v92, v93
    v_cvt_pk_bf16_f32 v51, v94, v95
    v_mfma_f32_32x32x16_bf16 v[80:95], v[36:39], v[44:47], 0
s_nop 0
    v_mfma_f32_32x32x16_bf16 v[80:95], v[40:43], v[48:51], v[80:95]
s_nop 11
    v_add_f32 v52, 0x358637bd, v88
    v_rcp_f32 v52, v52
s_nop 0
    v_mul_f32 v80, v80, v52
    v_mul_f32 v81, v81, v52
    v_mul_f32 v82, v82, v52
    v_mul_f32 v83, v83, v52
    v_mul_f32 v84, v84, v52
    v_mul_f32 v85, v85, v52
    v_mul_f32 v86, v86, v52
    v_mul_f32 v87, v87, v52
    v_cvt_pk_bf16_f32 v56, v80, v81
    v_cvt_pk_bf16_f32 v57, v82, v83
    v_cvt_pk_bf16_f32 v58, v84, v85
    v_cvt_pk_bf16_f32 v59, v86, v87
    buffer_store_dwordx4 v[56:59], v1, s[44:47], s68 offen sc1
s_nop 1
    v_cvt_pk_bf16_f32 v56, v104, v105
    v_cvt_pk_bf16_f32 v57, v106, v107
    v_cvt_pk_bf16_f32 v58, v108, v109
    v_cvt_pk_bf16_f32 v59, v110, v111
    v_lshl_or_b32 v32, v137, 16, v136
    v_lshl_or_b32 v33, v139, 16, v138
    v_lshl_or_b32 v34, v141, 16, v140
    v_lshl_or_b32 v35, v143, 16, v142
    v_bfe_u32 v52, v0, 4, 1
    v_mul_u32_u24 v52, 0x8000, v52
    v_lshl_or_b32 v52, v52, 16, v52
    v_xor_b32 v32, v32, v52
    v_xor_b32 v33, v33, v52
    v_xor_b32 v34, v34, v52
    v_xor_b32 v35, v35, v52
s_nop 1
    v_mfma_f32_32x32x16_bf16 v[80:95], v[32:35], v[56:59], 0
    v_cvt_pk_bf16_f32 v36, v160, v161
    v_cvt_pk_bf16_f32 v37, v162, v163
    v_cvt_pk_bf16_f32 v38, v164, v165
    v_cvt_pk_bf16_f32 v39, v166, v167
s_waitcnt vmcnt(7)
    v_cvt_pk_bf16_f32 v40, v168, v169
s_waitcnt vmcnt(5)
    v_cvt_pk_bf16_f32 v41, v170, v171
s_waitcnt vmcnt(3)
    v_cvt_pk_bf16_f32 v42, v172, v173
s_waitcnt vmcnt(1)
    v_cvt_pk_bf16_f32 v43, v174, v175
    s_lshl_b32 s68, s59, 2
    s_add_u32 s68, s68, s57
    s_lshl_b32 s68, s68, 5
    s_lshl_b32 s69, s60, 1
    s_add_u32 s68, s68, s69
    s_add_u32 s68, s68, 1
    s_lshl_b32 s68, s68, 10
    s_add_u32 s68, s68, 12582912
    v_max3_f32 v52, v80, v81, v82
    v_max3_f32 v53, v83, v84, v85
    v_max3_f32 v52, v52, v86, v87
    v_max_f32 v52, v52, v53
    v_mov_b32 v53, v52
s_nop 1
    v_permlane32_swap_b32 v52, v53
    v_max_f32 v52, v52, v53
    v_mul_f32 v52, 0xbfb8aa3b, v52
    v_mov_b32 v54, 0x3fb8aa3b
    v_fma_f32 v80, v80, v54, v52
    v_fma_f32 v81, v81, v54, v52
    v_fma_f32 v82, v82, v54, v52
    v_fma_f32 v83, v83, v54, v52
    v_fma_f32 v84, v84, v54, v52
    v_fma_f32 v85, v85, v54, v52
    v_fma_f32 v86, v86, v54, v52
    v_fma_f32 v87, v87, v54, v52
    v_exp_f32 v80, v80
    v_exp_f32 v81, v81
    v_exp_f32 v82, v82
    v_exp_f32 v83, v83
    v_exp_f32 v84, v84
    v_exp_f32 v85, v85
    v_exp_f32 v86, v86
    v_exp_f32 v87, v87
    v_add_f32 v54, v80, v81
    v_add_f32 v53, v82, v83
    v_add_f32 v54, v54, v84
    v_add_f32 v53, v53, v85
    v_add_f32 v54, v54, v86
    v_add_f32 v53, v53, v87
    v_add_f32 v54, v54, v53
    v_mov_b32 v53, v54
s_nop 1
    v_permlane32_swap_b32 v54, v53
    v_add_f32 v54, v54, v53
    v_rcp_f32 v54, v54
s_nop 0
    v_mul_f32 v80, v80, v54
    v_mul_f32 v81, v81, v54
    v_mul_f32 v82, v82, v54
    v_mul_f32 v83, v83, v54
    v_mul_f32 v84, v84, v54
    v_mul_f32 v85, v85, v54
    v_mul_f32 v86, v86, v54
    v_mul_f32 v87, v87, v54
    v_cvt_pk_bf16_f32 v44, v80, v81
    v_cvt_pk_bf16_f32 v45, v82, v83
    v_cvt_pk_bf16_f32 v46, v84, v85
    v_cvt_pk_bf16_f32 v47, v86, v87
    v_max3_f32 v52, v88, v89, v90
    v_max3_f32 v53, v91, v92, v93
    v_max3_f32 v52, v52, v94, v95
    v_max_f32 v52, v52, v53
    v_mov_b32 v53, v52
s_nop 1
    v_permlane32_swap_b32 v52, v53
    v_max_f32 v52, v52, v53
    v_mul_f32 v52, 0xbfb8aa3b, v52
    v_mov_b32 v54, 0x3fb8aa3b
    v_fma_f32 v88, v88, v54, v52
    v_fma_f32 v89, v89, v54, v52
    v_fma_f32 v90, v90, v54, v52
    v_fma_f32 v91, v91, v54, v52
    v_fma_f32 v92, v92, v54, v52
    v_fma_f32 v93, v93, v54, v52
    v_fma_f32 v94, v94, v54, v52
    v_fma_f32 v95, v95, v54, v52
    v_exp_f32 v88, v88
    v_exp_f32 v89, v89
    v_exp_f32 v90, v90
    v_exp_f32 v91, v91
    v_exp_f32 v92, v92
    v_exp_f32 v93, v93
    v_exp_f32 v94, v94
    v_exp_f32 v95, v95
    v_add_f32 v54, v88, v89
    v_add_f32 v53, v90, v91
    v_add_f32 v54, v54, v92
    v_add_f32 v53, v53, v93
    v_add_f32 v54, v54, v94
    v_add_f32 v53, v53, v95
    v_add_f32 v54, v54, v53
    v_mov_b32 v53, v54
s_nop 1
    v_permlane32_swap_b32 v54, v53
    v_add_f32 v54, v54, v53
    v_rcp_f32 v54, v54
s_nop 0
    v_mul_f32 v88, v88, v54
    v_mul_f32 v89, v89, v54
    v_mul_f32 v90, v90, v54
    v_mul_f32 v91, v91, v54
    v_mul_f32 v92, v92, v54
    v_mul_f32 v93, v93, v54
    v_mul_f32 v94, v94, v54
    v_mul_f32 v95, v95, v54
    v_cvt_pk_bf16_f32 v48, v88, v89
    v_cvt_pk_bf16_f32 v49, v90, v91
    v_cvt_pk_bf16_f32 v50, v92, v93
    v_cvt_pk_bf16_f32 v51, v94, v95
    v_mfma_f32_32x32x16_bf16 v[80:95], v[36:39], v[44:47], 0
s_nop 0
    v_mfma_f32_32x32x16_bf16 v[80:95], v[40:43], v[48:51], v[80:95]
s_nop 11
    v_add_f32 v52, 0x358637bd, v88
    v_rcp_f32 v52, v52
s_nop 0
    v_mul_f32 v80, v80, v52
    v_mul_f32 v81, v81, v52
    v_mul_f32 v82, v82, v52
    v_mul_f32 v83, v83, v52
    v_mul_f32 v84, v84, v52
    v_mul_f32 v85, v85, v52
    v_mul_f32 v86, v86, v52
    v_mul_f32 v87, v87, v52
    v_cvt_pk_bf16_f32 v56, v80, v81
    v_cvt_pk_bf16_f32 v57, v82, v83
    v_cvt_pk_bf16_f32 v58, v84, v85
    v_cvt_pk_bf16_f32 v59, v86, v87
    buffer_store_dwordx4 v[56:59], v1, s[44:47], s68 offen sc1
    s_lshl_b32 s68, s59, 7
    s_add_u32 s68, s68, 8519688
    v_mov_b32 v32, 0
    v_mov_b32 v20, 1
    s_mov_b64 exec, 1
    s_waitcnt vmcnt(0)
    s_cmp_eq_u32 s56, 7
    s_cbranch_scc1 K1_W7
    ds_add_u32 v21, v20
    s_waitcnt lgkmcnt(0)
    s_endpgm
K1_W7:
    s_mov_b32 s73, 0
K1_LPOLL:
    ds_read_b32 v33, v21
    s_waitcnt lgkmcnt(0)
    v_readfirstlane_b32 s74, v33
    s_add_u32 s73, s73, 1
s_nop 0
    s_cmp_ge_u32 s74, 3
    s_cbranch_scc1 K1_LDONE
    s_sleep 1
    s_cmp_lt_u32 s73, 200000
    s_cbranch_scc1 K1_LPOLL
K1_LDONE:
    buffer_atomic_add v20, v32, s[44:47], s68 offen sc1
    s_endpgm
K1_END:
    s_endpgm
K2_ENTRY:
    s_mov_b32 s26, s56
    s_mov_b32 s27, s59
    v_mov_b32 v4, v0
    s_load_dwordx16 s[4:19], s[0:1], 0
    s_load_dwordx4 s[20:23], s[0:1], 64
    s_load_dwordx2 s[24:25], s[0:1], 80
    s_mov_b32 s44, s26
    v_lshlrev_b32 v1, 4, v4
    s_and_b32 s45, s2, 7
    s_lshr_b32 s46, s2, 3
    s_lshr_b32 s54, s46, 3
    s_lshl_b32 s47, s45, 2
    s_add_u32 s47, s47, s54
    s_and_b32 s48, s46, 7
    s_lshl_b32 s54, s54, 1
    s_add_u32 s54, s54, s48
    s_and_b32 s54, s54, 7
    s_mul_i32 s49, s54, 11
    s_add_u32 s49, s49, s44
    s_lshl_b32 s49, s49, 10
    s_lshl_b32 s46, s54, 2
    s_add_u32 s46, s46, s44
    s_lshl_b32 s46, s46, 10
    s_lshl_b32 s52, s47, 16
    s_add_u32 s52, s52, 12582912
    s_mul_i32 s53, s44, 20480
    s_lshr_b32 s54, s44, 1
    s_mul_i32 s56, s54, 88064
    s_sub_u32 s57, 88064, s56
    v_add_u32 v2, s56, v1
    v_add_u32 v3, s57, v1
    s_mul_i32 s56, s54, 32768
    s_sub_u32 s57, 32768, s56
    v_add_u32 v5, s56, v1
    v_add_u32 v6, s57, v1
    v_lshrrev_b32 v10, 3, v4
    v_bfe_u32 v11, v4, 4, 1
    v_lshlrev_b32 v11, 2, v11
    v_and_b32 v12, 7, v4
    v_xor_b32 v12, v12, v11
    v_lshlrev_b32 v10, 10, v10
    v_lshl_add_u32 v10, v12, 4, v10
    s_lshl_b32 s56, s48, 7
    v_add_u32 v7, s56, v10
    v_bfe_u32 v10, v4, 2, 2
    v_lshrrev_b32 v11, 5, v4
    v_lshl_add_u32 v11, v11, 3, v10
    v_lshlrev_b32 v11, 7, v11
    v_and_b32 v12, 1, v4
    v_lshl_add_u32 v11, v12, 5, v11
    v_bfe_u32 v12, v4, 4, 1
    v_lshl_add_u32 v11, v12, 4, v11
    v_bfe_u32 v12, v4, 1, 1
    v_lshl_add_u32 v11, v12, 3, v11
    v_bfe_u32 v12, v4, 3, 1
    s_and_b32 s56, s44, 1
    v_xor_b32 v12, s56, v12
    v_lshl_add_u32 v8, v12, 6, v11
    v_add_u32 v8, s53, v8
    v_xor_b32 v9, 64, v8
    s_waitcnt lgkmcnt(0)
    s_mov_b32 s28, s24
    s_and_b32 s29, s25, 0xffff
    s_mov_b32 s30, 0xf00000
    s_mov_b32 s31, 0x00020000
    s_mul_i32 s54, s47, 176128
    s_add_u32 s64, s24, s54
    s_addc_u32 s65, s25, 0
    s_and_b32 s65, s65, 0xffff
    s_mov_b32 s66, 176128
    s_mov_b32 s67, 0x00020000
    s_mov_b32 s68, s18
    s_and_b32 s69, s19, 0xffff
    s_mov_b32 s70, 0x158000
    s_mov_b32 s71, 0x00020000
    s_mov_b32 s72, s10
    s_and_b32 s73, s11, 0xffff
    s_mov_b32 s74, 0x80000
    s_mov_b32 s75, 0x00020000
    s_mov_b32 s50, s46
    s_mov_b32 s51, s49
    s_lshr_b32 s58, s47, 1
    s_lshl_b32 s58, s58, 7
    s_add_u32 s58, s58, 8519684
    v_mov_b32 v14, 0
    s_mov_b64 exec, 1
    buffer_load_dword v15, v14, s[28:31], s58 offen sc1
    s_mov_b64 exec, -1
    s_lshl_b32 s63, s51, 4
    s_add_u32 m0, s53, 0
    s_add_u32 s61, s63, 7168
    buffer_load_dwordx4 v7, s[68:71], s63 offen lds
    buffer_load_dwordx4 v7, s[68:71], s61 offen offset:1024 lds
    s_add_u32 s51, s51, 4096
    s_sub_u32 s62, s51, 88064
    s_cmp_ge_u32 s51, 88064
    s_cselect_b32 s51, s62, s51
    s_lshl_b32 s63, s51, 4
    s_add_u32 m0, s53, 2048
    s_add_u32 s61, s63, 7168
    buffer_load_dwordx4 v7, s[68:71], s63 offen lds
    buffer_load_dwordx4 v7, s[68:71], s61 offen offset:1024 lds
    s_add_u32 s51, s51, 4096
    s_sub_u32 s62, s51, 88064
    s_cmp_ge_u32 s51, 88064
    s_cselect_b32 s51, s62, s51
    s_lshl_b32 s63, s51, 4
    s_add_u32 m0, s53, 4096
    s_add_u32 s61, s63, 7168
    buffer_load_dwordx4 v7, s[68:71], s63 offen lds
    buffer_load_dwordx4 v7, s[68:71], s61 offen offset:1024 lds
    s_add_u32 s51, s51, 4096
    s_sub_u32 s62, s51, 88064
    s_cmp_ge_u32 s51, 88064
    s_cselect_b32 s51, s62, s51
    s_lshl_b32 s63, s51, 4
    s_add_u32 m0, s53, 6144
    s_add_u32 s61, s63, 7168
    buffer_load_dwordx4 v7, s[68:71], s63 offen lds
    buffer_load_dwordx4 v7, s[68:71], s61 offen offset:1024 lds
    s_add_u32 s51, s51, 4096
    s_sub_u32 s62, s51, 88064
    s_cmp_ge_u32 s51, 88064
    s_cselect_b32 s51, s62, s51
    s_lshl_b32 s63, s51, 4
    s_add_u32 m0, s53, 8192
    s_add_u32 s61, s63, 7168
    buffer_load_dwordx4 v7, s[68:71], s63 offen lds
    buffer_load_dwordx4 v7, s[68:71], s61 offen offset:1024 lds
    s_add_u32 s51, s51, 4096
    s_sub_u32 s62, s51, 88064
    s_cmp_ge_u32 s51, 88064
    s_cselect_b32 s51, s62, s51
    s_lshl_b32 s63, s51, 4
    s_add_u32 m0, s53, 10240
    s_add_u32 s61, s63, 7168
    buffer_load_dwordx4 v7, s[68:71], s63 offen lds
    buffer_load_dwordx4 v7, s[68:71], s61 offen offset:1024 lds
    s_add_u32 s51, s51, 4096
    s_sub_u32 s62, s51, 88064
    s_cmp_ge_u32 s51, 88064
    s_cselect_b32 s51, s62, s51
    s_lshl_b32 s63, s51, 4
    s_add_u32 m0, s53, 12288
    s_add_u32 s61, s63, 7168
    buffer_load_dwordx4 v7, s[68:71], s63 offen lds
    buffer_load_dwordx4 v7, s[68:71], s61 offen offset:1024 lds
    s_add_u32 s51, s51, 4096
    s_sub_u32 s62, s51, 88064
    s_cmp_ge_u32 s51, 88064
    s_cselect_b32 s51, s62, s51
    s_lshl_b32 s63, s51, 4
    s_add_u32 m0, s53, 14336
    s_add_u32 s61, s63, 7168
    buffer_load_dwordx4 v7, s[68:71], s63 offen lds
    buffer_load_dwordx4 v7, s[68:71], s61 offen offset:1024 lds
    s_add_u32 s51, s51, 4096
    s_sub_u32 s62, s51, 88064
    s_cmp_ge_u32 s51, 88064
    s_cselect_b32 s51, s62, s51
    s_lshl_b32 s63, s51, 4
    s_add_u32 m0, s53, 16384
    s_add_u32 s61, s63, 7168
    buffer_load_dwordx4 v7, s[68:71], s63 offen lds
    buffer_load_dwordx4 v7, s[68:71], s61 offen offset:1024 lds
    s_add_u32 s51, s51, 4096
    s_sub_u32 s62, s51, 88064
    s_cmp_ge_u32 s51, 88064
    s_cselect_b32 s51, s62, s51
    s_lshl_b32 s63, s51, 4
    s_add_u32 m0, s53, 18432
    s_add_u32 s61, s63, 7168
    buffer_load_dwordx4 v7, s[68:71], s63 offen lds
    buffer_load_dwordx4 v7, s[68:71], s61 offen offset:1024 lds
    s_add_u32 s51, s51, 4096
    s_sub_u32 s62, s51, 88064
    s_cmp_ge_u32 s51, 88064
    s_cselect_b32 s51, s62, s51
s_waitcnt vmcnt(20)
    v_readfirstlane_b32 s60, v15
    v_mov_b32 v12, 162048
    s_mov_b64 exec, 1
s_nop 1
    s_cmp_ge_u32 s60, 16
    s_cbranch_scc1 K2_POLLED
    s_mov_b64 exec, -1
    v_mov_b32 v12, 162048
    s_mov_b32 s59, 0
    s_cmp_eq_u32 s44, 0
    s_cbranch_scc0 K2_LWAIT
    s_lshr_b32 s54, s47, 1
    s_lshl_b32 s54, s54, 7
    s_add_u32 s54, s54, 8519684
    v_mov_b32 v14, 0
    s_mov_b64 exec, 1
    K2_POLL:
    buffer_load_dword v13, v14, s[28:31], s54 offen sc1
    s_waitcnt vmcnt(0)
    v_readfirstlane_b32 s60, v13
    s_add_u32 s59, s59, 1
    s_nop 3
    s_cmp_ge_u32 s60, 16
    s_cbranch_scc1 K2_POLLED
    s_sleep 6
    s_cmp_lt_u32 s59, 40000
    s_cbranch_scc1 K2_POLL
    K2_POLLED:
    v_mov_b32 v13, 1
    ds_write_b32 v12, v13 offset:4
    s_waitcnt lgkmcnt(0)
    s_mov_b64 exec, -1
    s_branch K2_GO
    K2_LWAIT:
    s_sleep 1
    ds_read_b32 v13, v12 offset:4
    s_waitcnt lgkmcnt(0)
    v_readfirstlane_b32 s60, v13
    s_add_u32 s59, s59, 1
    s_nop 3
    s_cmp_ge_u32 s60, 1
    s_cbranch_scc1 K2_GO
    s_cmp_lt_u32 s59, 400000
    s_cbranch_scc1 K2_LWAIT
K2_GO:
    buffer_load_dwordx4 v[16:19], v2, s[64:67], s49 offen sc1
    buffer_load_dwordx4 v[20:23], v3, s[64:67], s49 offen sc1
    s_add_u32 s49, s49, 4096
    s_sub_u32 s62, s49, 88064
    s_cmp_ge_u32 s49, 88064
    s_cselect_b32 s49, s62, s49
    buffer_load_dwordx4 v[24:27], v2, s[64:67], s49 offen sc1
    buffer_load_dwordx4 v[28:31], v3, s[64:67], s49 offen sc1
    s_add_u32 s49, s49, 4096
    s_sub_u32 s62, s49, 88064
    s_cmp_ge_u32 s49, 88064
    s_cselect_b32 s49, s62, s49
    buffer_load_dwordx4 v[32:35], v2, s[64:67], s49 offen sc1
    buffer_load_dwordx4 v[36:39], v3, s[64:67], s49 offen sc1
    s_add_u32 s49, s49, 4096
    s_sub_u32 s62, s49, 88064
    s_cmp_ge_u32 s49, 88064
    s_cselect_b32 s49, s62, s49
    buffer_load_dwordx4 v[40:43], v2, s[64:67], s49 offen sc1
    buffer_load_dwordx4 v[44:47], v3, s[64:67], s49 offen sc1
    s_add_u32 s49, s49, 4096
    s_sub_u32 s62, s49, 88064
    s_cmp_ge_u32 s49, 88064
    s_cselect_b32 s49, s62, s49
    buffer_load_dwordx4 v[48:51], v2, s[64:67], s49 offen sc1
    buffer_load_dwordx4 v[52:55], v3, s[64:67], s49 offen sc1
    s_add_u32 s49, s49, 4096
    s_sub_u32 s62, s49, 88064
    s_cmp_ge_u32 s49, 88064
    s_cselect_b32 s49, s62, s49
    buffer_load_dwordx4 v[56:59], v2, s[64:67], s49 offen sc1
    buffer_load_dwordx4 v[60:63], v3, s[64:67], s49 offen sc1
    s_add_u32 s49, s49, 4096
    s_sub_u32 s62, s49, 88064
    s_cmp_ge_u32 s49, 88064
    s_cselect_b32 s49, s62, s49
    buffer_load_dwordx4 v[64:67], v2, s[64:67], s49 offen sc1
    buffer_load_dwordx4 v[68:71], v3, s[64:67], s49 offen sc1
    s_add_u32 s49, s49, 4096
    s_sub_u32 s62, s49, 88064
    s_cmp_ge_u32 s49, 88064
    s_cselect_b32 s49, s62, s49
    buffer_load_dwordx4 v[72:75], v2, s[64:67], s49 offen sc1
    buffer_load_dwordx4 v[76:79], v3, s[64:67], s49 offen sc1
    s_add_u32 s49, s49, 4096
    s_sub_u32 s62, s49, 88064
    s_cmp_ge_u32 s49, 88064
    s_cselect_b32 s49, s62, s49
    buffer_load_dwordx4 v[80:83], v2, s[64:67], s49 offen sc1
    buffer_load_dwordx4 v[84:87], v3, s[64:67], s49 offen sc1
    s_add_u32 s49, s49, 4096
    s_sub_u32 s62, s49, 88064
    s_cmp_ge_u32 s49, 88064
    s_cselect_b32 s49, s62, s49
    buffer_load_dwordx4 v[88:91], v2, s[64:67], s49 offen sc1
    buffer_load_dwordx4 v[92:95], v3, s[64:67], s49 offen sc1
    s_add_u32 s49, s49, 4096
    s_sub_u32 s62, s49, 88064
    s_cmp_ge_u32 s49, 88064
    s_cselect_b32 s49, s62, s49
    s_mov_b32 s32, s4
    s_and_b32 s33, s5, 0xffff
    s_mov_b32 s34, 0x200000
    s_mov_b32 s35, 0x00020000
    s_mov_b32 s36, s20
    s_and_b32 s37, s21, 0xffff
    s_mov_b32 s38, 0x200000
    s_mov_b32 s39, 0x00020000
s_waitcnt vmcnt(38)
    ds_read_b64_tr_b16 v[128:129], v8 offset:0
    ds_read_b64_tr_b16 v[130:131], v8 offset:512
    ds_read_b64_tr_b16 v[132:133], v9 offset:0
    ds_read_b64_tr_b16 v[134:135], v9 offset:512
s_waitcnt vmcnt(36)
    ds_read_b64_tr_b16 v[136:137], v8 offset:2048
    ds_read_b64_tr_b16 v[138:139], v8 offset:2560
    ds_read_b64_tr_b16 v[140:141], v9 offset:2048
    ds_read_b64_tr_b16 v[142:143], v9 offset:2560
s_waitcnt vmcnt(34)
    ds_read_b64_tr_b16 v[144:145], v8 offset:4096
    ds_read_b64_tr_b16 v[146:147], v8 offset:4608
    ds_read_b64_tr_b16 v[148:149], v9 offset:4096
    ds_read_b64_tr_b16 v[150:151], v9 offset:4608
s_waitcnt vmcnt(19) lgkmcnt(10)
    v_mfma_f32_32x32x16_bf16 v[192:207], v[128:131], v[16:19], 0
s_waitcnt lgkmcnt(8)
    v_mfma_f32_32x32x16_bf16 v[208:223], v[132:135], v[16:19], 0
s_waitcnt vmcnt(18)
    v_mfma_f32_32x32x16_bf16 v[224:239], v[128:131], v[20:23], 0
    v_mfma_f32_32x32x16_bf16 v[240:255], v[132:135], v[20:23], 0
    buffer_load_dwordx4 v[96:99], v2, s[64:67], s49 offen sc1
    buffer_load_dwordx4 v[100:103], v3, s[64:67], s49 offen sc1
    s_add_u32 s49, s49, 4096
    s_sub_u32 s62, s49, 88064
    s_cmp_ge_u32 s49, 88064
    s_cselect_b32 s49, s62, s49
    s_lshl_b32 s63, s51, 4
    s_add_u32 m0, s53, 0
    s_add_u32 s61, s63, 7168
    buffer_load_dwordx4 v7, s[68:71], s63 offen lds
    buffer_load_dwordx4 v7, s[68:71], s61 offen offset:1024 lds
    s_add_u32 s51, s51, 4096
    s_sub_u32 s62, s51, 88064
    s_cmp_ge_u32 s51, 88064
    s_cselect_b32 s51, s62, s51
    ds_read_b64_tr_b16 v[152:153], v8 offset:6144
    ds_read_b64_tr_b16 v[154:155], v8 offset:6656
    ds_read_b64_tr_b16 v[156:157], v9 offset:6144
    ds_read_b64_tr_b16 v[158:159], v9 offset:6656
s_waitcnt vmcnt(21) lgkmcnt(10)
    v_mfma_f32_32x32x16_bf16 v[192:207], v[136:139], v[24:27], v[192:207]
s_waitcnt lgkmcnt(8)
    v_mfma_f32_32x32x16_bf16 v[208:223], v[140:143], v[24:27], v[208:223]
s_waitcnt vmcnt(20)
    v_mfma_f32_32x32x16_bf16 v[224:239], v[136:139], v[28:31], v[224:239]
    v_mfma_f32_32x32x16_bf16 v[240:255], v[140:143], v[28:31], v[240:255]
    buffer_load_dwordx4 v[104:107], v2, s[64:67], s49 offen sc1
    buffer_load_dwordx4 v[108:111], v3, s[64:67], s49 offen sc1
    s_add_u32 s49, s49, 4096
    s_sub_u32 s62, s49, 88064
    s_cmp_ge_u32 s49, 88064
    s_cselect_b32 s49, s62, s49
    s_lshl_b32 s63, s51, 4
    s_add_u32 m0, s53, 2048
    s_add_u32 s61, s63, 7168
    buffer_load_dwordx4 v7, s[68:71], s63 offen lds
    buffer_load_dwordx4 v7, s[68:71], s61 offen offset:1024 lds
    s_add_u32 s51, s51, 4096
    s_sub_u32 s62, s51, 88064
    s_cmp_ge_u32 s51, 88064
    s_cselect_b32 s51, s62, s51
    ds_read_b64_tr_b16 v[128:129], v8 offset:8192
    ds_read_b64_tr_b16 v[130:131], v8 offset:8704
    ds_read_b64_tr_b16 v[132:133], v9 offset:8192
    ds_read_b64_tr_b16 v[134:135], v9 offset:8704
s_waitcnt vmcnt(23) lgkmcnt(10)
    v_mfma_f32_32x32x16_bf16 v[192:207], v[144:147], v[32:35], v[192:207]
s_waitcnt lgkmcnt(8)
    v_mfma_f32_32x32x16_bf16 v[208:223], v[148:151], v[32:35], v[208:223]
s_waitcnt vmcnt(22)
    v_mfma_f32_32x32x16_bf16 v[224:239], v[144:147], v[36:39], v[224:239]
    v_mfma_f32_32x32x16_bf16 v[240:255], v[148:151], v[36:39], v[240:255]
    buffer_load_dwordx4 v[112:115], v2, s[64:67], s49 offen sc1
    buffer_load_dwordx4 v[116:119], v3, s[64:67], s49 offen sc1
    s_add_u32 s49, s49, 4096
    s_sub_u32 s62, s49, 88064
    s_cmp_ge_u32 s49, 88064
    s_cselect_b32 s49, s62, s49
    s_lshl_b32 s63, s51, 4
    s_add_u32 m0, s53, 4096
    s_add_u32 s61, s63, 7168
    buffer_load_dwordx4 v7, s[68:71], s63 offen lds
    buffer_load_dwordx4 v7, s[68:71], s61 offen offset:1024 lds
    s_add_u32 s51, s51, 4096
    s_sub_u32 s62, s51, 88064
    s_cmp_ge_u32 s51, 88064
    s_cselect_b32 s51, s62, s51
    ds_read_b64_tr_b16 v[136:137], v8 offset:10240
    ds_read_b64_tr_b16 v[138:139], v8 offset:10752
    ds_read_b64_tr_b16 v[140:141], v9 offset:10240
    ds_read_b64_tr_b16 v[142:143], v9 offset:10752
s_waitcnt vmcnt(25) lgkmcnt(10)
    v_mfma_f32_32x32x16_bf16 v[192:207], v[152:155], v[40:43], v[192:207]
s_waitcnt lgkmcnt(8)
    v_mfma_f32_32x32x16_bf16 v[208:223], v[156:159], v[40:43], v[208:223]
s_waitcnt vmcnt(24)
    v_mfma_f32_32x32x16_bf16 v[224:239], v[152:155], v[44:47], v[224:239]
    v_mfma_f32_32x32x16_bf16 v[240:255], v[156:159], v[44:47], v[240:255]
    buffer_load_dwordx4 v[120:123], v2, s[64:67], s49 offen sc1
    buffer_load_dwordx4 v[124:127], v3, s[64:67], s49 offen sc1
    s_add_u32 s49, s49, 4096
    s_sub_u32 s62, s49, 88064
    s_cmp_ge_u32 s49, 88064
    s_cselect_b32 s49, s62, s49
    s_lshl_b32 s63, s51, 4
    s_add_u32 m0, s53, 6144
    s_add_u32 s61, s63, 7168
    buffer_load_dwordx4 v7, s[68:71], s63 offen lds
    buffer_load_dwordx4 v7, s[68:71], s61 offen offset:1024 lds
    s_add_u32 s51, s51, 4096
    s_sub_u32 s62, s51, 88064
    s_cmp_ge_u32 s51, 88064
    s_cselect_b32 s51, s62, s51
    ds_read_b64_tr_b16 v[144:145], v8 offset:12288
    ds_read_b64_tr_b16 v[146:147], v8 offset:12800
    ds_read_b64_tr_b16 v[148:149], v9 offset:12288
    ds_read_b64_tr_b16 v[150:151], v9 offset:12800
s_waitcnt vmcnt(27) lgkmcnt(10)
    v_mfma_f32_32x32x16_bf16 v[192:207], v[128:131], v[48:51], v[192:207]
s_waitcnt lgkmcnt(8)
    v_mfma_f32_32x32x16_bf16 v[208:223], v[132:135], v[48:51], v[208:223]
s_waitcnt vmcnt(26)
    v_mfma_f32_32x32x16_bf16 v[224:239], v[128:131], v[52:55], v[224:239]
    v_mfma_f32_32x32x16_bf16 v[240:255], v[132:135], v[52:55], v[240:255]
    buffer_load_dwordx4 v[16:19], v2, s[64:67], s49 offen sc1
    buffer_load_dwordx4 v[20:23], v3, s[64:67], s49 offen sc1
    s_add_u32 s49, s49, 4096
    s_sub_u32 s62, s49, 88064
    s_cmp_ge_u32 s49, 88064
    s_cselect_b32 s49, s62, s49
    s_lshl_b32 s63, s51, 4
    s_add_u32 m0, s53, 8192
    s_add_u32 s61, s63, 7168
    buffer_load_dwordx4 v7, s[68:71], s63 offen lds
    buffer_load_dwordx4 v7, s[68:71], s61 offen offset:1024 lds
    s_add_u32 s51, s51, 4096
    s_sub_u32 s62, s51, 88064
    s_cmp_ge_u32 s51, 88064
    s_cselect_b32 s51, s62, s51
    ds_read_b64_tr_b16 v[152:153], v8 offset:14336
    ds_read_b64_tr_b16 v[154:155], v8 offset:14848
    ds_read_b64_tr_b16 v[156:157], v9 offset:14336
    ds_read_b64_tr_b16 v[158:159], v9 offset:14848
s_waitcnt vmcnt(29) lgkmcnt(10)
    v_mfma_f32_32x32x16_bf16 v[192:207], v[136:139], v[56:59], v[192:207]
s_waitcnt lgkmcnt(8)
    v_mfma_f32_32x32x16_bf16 v[208:223], v[140:143], v[56:59], v[208:223]
s_waitcnt vmcnt(28)
    v_mfma_f32_32x32x16_bf16 v[224:239], v[136:139], v[60:63], v[224:239]
    v_mfma_f32_32x32x16_bf16 v[240:255], v[140:143], v[60:63], v[240:255]
    buffer_load_dwordx4 v[24:27], v2, s[64:67], s49 offen sc1
    buffer_load_dwordx4 v[28:31], v3, s[64:67], s49 offen sc1
    s_add_u32 s49, s49, 4096
    s_sub_u32 s62, s49, 88064
    s_cmp_ge_u32 s49, 88064
    s_cselect_b32 s49, s62, s49
    s_lshl_b32 s63, s51, 4
    s_add_u32 m0, s53, 10240
    s_add_u32 s61, s63, 7168
    buffer_load_dwordx4 v7, s[68:71], s63 offen lds
    buffer_load_dwordx4 v7, s[68:71], s61 offen offset:1024 lds
    s_add_u32 s51, s51, 4096
    s_sub_u32 s62, s51, 88064
    s_cmp_ge_u32 s51, 88064
    s_cselect_b32 s51, s62, s51
    ds_read_b64_tr_b16 v[128:129], v8 offset:16384
    ds_read_b64_tr_b16 v[130:131], v8 offset:16896
    ds_read_b64_tr_b16 v[132:133], v9 offset:16384
    ds_read_b64_tr_b16 v[134:135], v9 offset:16896
s_waitcnt vmcnt(31) lgkmcnt(10)
    v_mfma_f32_32x32x16_bf16 v[192:207], v[144:147], v[64:67], v[192:207]
s_waitcnt lgkmcnt(8)
    v_mfma_f32_32x32x16_bf16 v[208:223], v[148:151], v[64:67], v[208:223]
s_waitcnt vmcnt(30)
    v_mfma_f32_32x32x16_bf16 v[224:239], v[144:147], v[68:71], v[224:239]
    v_mfma_f32_32x32x16_bf16 v[240:255], v[148:151], v[68:71], v[240:255]
    buffer_load_dwordx4 v[32:35], v2, s[64:67], s49 offen sc1
    buffer_load_dwordx4 v[36:39], v3, s[64:67], s49 offen sc1
    s_add_u32 s49, s49, 4096
    s_sub_u32 s62, s49, 88064
    s_cmp_ge_u32 s49, 88064
    s_cselect_b32 s49, s62, s49
    s_lshl_b32 s63, s51, 4
    s_add_u32 m0, s53, 12288
    s_add_u32 s61, s63, 7168
    buffer_load_dwordx4 v7, s[68:71], s63 offen lds
    buffer_load_dwordx4 v7, s[68:71], s61 offen offset:1024 lds
    s_add_u32 s51, s51, 4096
    s_sub_u32 s62, s51, 88064
    s_cmp_ge_u32 s51, 88064
    s_cselect_b32 s51, s62, s51
    ds_read_b64_tr_b16 v[136:137], v8 offset:18432
    ds_read_b64_tr_b16 v[138:139], v8 offset:18944
    ds_read_b64_tr_b16 v[140:141], v9 offset:18432
    ds_read_b64_tr_b16 v[142:143], v9 offset:18944
s_waitcnt vmcnt(33) lgkmcnt(10)
    v_mfma_f32_32x32x16_bf16 v[192:207], v[152:155], v[72:75], v[192:207]
s_waitcnt lgkmcnt(8)
    v_mfma_f32_32x32x16_bf16 v[208:223], v[156:159], v[72:75], v[208:223]
s_waitcnt vmcnt(32)
    v_mfma_f32_32x32x16_bf16 v[224:239], v[152:155], v[76:79], v[224:239]
    v_mfma_f32_32x32x16_bf16 v[240:255], v[156:159], v[76:79], v[240:255]
    buffer_load_dwordx4 v[40:43], v2, s[64:67], s49 offen sc1
    buffer_load_dwordx4 v[44:47], v3, s[64:67], s49 offen sc1
    s_add_u32 s49, s49, 4096
    s_sub_u32 s62, s49, 88064
    s_cmp_ge_u32 s49, 88064
    s_cselect_b32 s49, s62, s49
    s_lshl_b32 s63, s51, 4
    s_add_u32 m0, s53, 14336
    s_add_u32 s61, s63, 7168
    buffer_load_dwordx4 v7, s[68:71], s63 offen lds
    buffer_load_dwordx4 v7, s[68:71], s61 offen offset:1024 lds
    s_add_u32 s51, s51, 4096
    s_sub_u32 s62, s51, 88064
    s_cmp_ge_u32 s51, 88064
    s_cselect_b32 s51, s62, s51
s_waitcnt vmcnt(28)
    ds_read_b64_tr_b16 v[144:145], v8 offset:0
    ds_read_b64_tr_b16 v[146:147], v8 offset:512
    ds_read_b64_tr_b16 v[148:149], v9 offset:0
    ds_read_b64_tr_b16 v[150:151], v9 offset:512
s_waitcnt lgkmcnt(10)
    v_mfma_f32_32x32x16_bf16 v[192:207], v[128:131], v[80:83], v[192:207]
s_waitcnt lgkmcnt(8)
    v_mfma_f32_32x32x16_bf16 v[208:223], v[132:135], v[80:83], v[208:223]
    v_mfma_f32_32x32x16_bf16 v[224:239], v[128:131], v[84:87], v[224:239]
    v_mfma_f32_32x32x16_bf16 v[240:255], v[132:135], v[84:87], v[240:255]
    s_lshr_b32 s58, s47, 1
    s_lshl_b32 s58, s58, 7
    s_add_u32 s58, s58, 8519688
    v_mov_b32 v14, 0
    s_mov_b64 exec, 1
    buffer_load_dword v15, v14, s[28:31], s58 offen sc1
    s_mov_b64 exec, -1
    buffer_load_dwordx4 v[48:51], v2, s[64:67], s49 offen sc1
    buffer_load_dwordx4 v[52:55], v3, s[64:67], s49 offen sc1
    s_add_u32 s49, s49, 4096
    s_sub_u32 s62, s49, 88064
    s_cmp_ge_u32 s49, 88064
    s_cselect_b32 s49, s62, s49
    s_lshl_b32 s63, s51, 4
    s_add_u32 m0, s53, 16384
    s_add_u32 s61, s63, 7168
    buffer_load_dwordx4 v7, s[68:71], s63 offen lds
    buffer_load_dwordx4 v7, s[68:71], s61 offen offset:1024 lds
    s_add_u32 s51, s51, 4096
    s_sub_u32 s62, s51, 88064
    s_cmp_ge_u32 s51, 88064
    s_cselect_b32 s51, s62, s51
s_waitcnt vmcnt(29)
    ds_read_b64_tr_b16 v[152:153], v8 offset:2048
    ds_read_b64_tr_b16 v[154:155], v8 offset:2560
    ds_read_b64_tr_b16 v[156:157], v9 offset:2048
    ds_read_b64_tr_b16 v[158:159], v9 offset:2560
s_waitcnt lgkmcnt(10)
    v_mfma_f32_32x32x16_bf16 v[192:207], v[136:139], v[88:91], v[192:207]
s_waitcnt lgkmcnt(8)
    v_mfma_f32_32x32x16_bf16 v[208:223], v[140:143], v[88:91], v[208:223]
    v_mfma_f32_32x32x16_bf16 v[224:239], v[136:139], v[92:95], v[224:239]
    v_mfma_f32_32x32x16_bf16 v[240:255], v[140:143], v[92:95], v[240:255]
    buffer_load_dwordx4 v[56:59], v2, s[64:67], s49 offen sc1
    buffer_load_dwordx4 v[60:63], v3, s[64:67], s49 offen sc1
    s_add_u32 s49, s49, 4096
    s_sub_u32 s62, s49, 88064
    s_cmp_ge_u32 s49, 88064
    s_cselect_b32 s49, s62, s49
    s_lshl_b32 s63, s51, 4
    s_add_u32 m0, s53, 18432
    s_add_u32 s61, s63, 7168
    buffer_load_dwordx4 v7, s[68:71], s63 offen lds
    buffer_load_dwordx4 v7, s[68:71], s61 offen offset:1024 lds
    s_add_u32 s51, s51, 4096
    s_sub_u32 s62, s51, 88064
    s_cmp_ge_u32 s51, 88064
    s_cselect_b32 s51, s62, s51
s_waitcnt vmcnt(29)
    ds_read_b64_tr_b16 v[128:129], v8 offset:4096
    ds_read_b64_tr_b16 v[130:131], v8 offset:4608
    ds_read_b64_tr_b16 v[132:133], v9 offset:4096
    ds_read_b64_tr_b16 v[134:135], v9 offset:4608
s_waitcnt lgkmcnt(10)
    v_mfma_f32_32x32x16_bf16 v[192:207], v[144:147], v[96:99], v[192:207]
s_waitcnt lgkmcnt(8)
    v_mfma_f32_32x32x16_bf16 v[208:223], v[148:151], v[96:99], v[208:223]
    v_mfma_f32_32x32x16_bf16 v[224:239], v[144:147], v[100:103], v[224:239]
    v_mfma_f32_32x32x16_bf16 v[240:255], v[148:151], v[100:103], v[240:255]
    buffer_load_dwordx4 v[64:67], v2, s[64:67], s49 offen sc1
    buffer_load_dwordx4 v[68:71], v3, s[64:67], s49 offen sc1
    s_add_u32 s49, s49, 4096
    s_sub_u32 s62, s49, 88064
    s_cmp_ge_u32 s49, 88064
    s_cselect_b32 s49, s62, s49
    s_lshl_b32 s63, s51, 4
    s_add_u32 m0, s53, 0
    s_add_u32 s61, s63, 7168
    buffer_load_dwordx4 v7, s[68:71], s63 offen lds
    buffer_load_dwordx4 v7, s[68:71], s61 offen offset:1024 lds
    s_add_u32 s51, s51, 4096
    s_sub_u32 s62, s51, 88064
    s_cmp_ge_u32 s51, 88064
    s_cselect_b32 s51, s62, s51
s_waitcnt vmcnt(29)
    ds_read_b64_tr_b16 v[136:137], v8 offset:6144
    ds_read_b64_tr_b16 v[138:139], v8 offset:6656
    ds_read_b64_tr_b16 v[140:141], v9 offset:6144
    ds_read_b64_tr_b16 v[142:143], v9 offset:6656
s_waitcnt lgkmcnt(10)
    v_mfma_f32_32x32x16_bf16 v[192:207], v[152:155], v[104:107], v[192:207]
s_waitcnt lgkmcnt(8)
    v_mfma_f32_32x32x16_bf16 v[208:223], v[156:159], v[104:107], v[208:223]
    v_mfma_f32_32x32x16_bf16 v[224:239], v[152:155], v[108:111], v[224:239]
    v_mfma_f32_32x32x16_bf16 v[240:255], v[156:159], v[108:111], v[240:255]
    s_cmp_ge_u32 s44, 2
    s_cselect_b32 s49, 0x700000, s49
    buffer_load_dwordx4 v[72:75], v2, s[64:67], s49 offen sc1
    buffer_load_dwordx4 v[76:79], v3, s[64:67], s49 offen sc1
    s_cmp_ge_u32 s44, 2
    s_cselect_b32 s51, 0x700000, s51
    s_lshl_b32 s63, s51, 4
    s_add_u32 m0, s53, 2048
    s_add_u32 s61, s63, 7168
    buffer_load_dwordx4 v7, s[68:71], s63 offen lds
    buffer_load_dwordx4 v7, s[68:71], s61 offen offset:1024 lds
s_waitcnt vmcnt(29)
    ds_read_b64_tr_b16 v[144:145], v8 offset:8192
    ds_read_b64_tr_b16 v[146:147], v8 offset:8704
    ds_read_b64_tr_b16 v[148:149], v9 offset:8192
    ds_read_b64_tr_b16 v[150:151], v9 offset:8704
s_waitcnt lgkmcnt(10)
    v_mfma_f32_32x32x16_bf16 v[192:207], v[128:131], v[112:115], v[192:207]
s_waitcnt lgkmcnt(8)
    v_mfma_f32_32x32x16_bf16 v[208:223], v[132:135], v[112:115], v[208:223]
    v_mfma_f32_32x32x16_bf16 v[224:239], v[128:131], v[116:119], v[224:239]
    v_mfma_f32_32x32x16_bf16 v[240:255], v[132:135], v[116:119], v[240:255]
s_waitcnt vmcnt(16)
    v_readfirstlane_b32 s60, v15
s_nop 1
    s_cmp_ge_u32 s60, 16
    s_cbranch_scc1 K2_OOK
    s_mov_b32 s59, 0
    s_mov_b64 exec, 1
    K2_OPOLL:
    s_sleep 6
    buffer_load_dword v15, v14, s[28:31], s58 offen sc1
    s_waitcnt vmcnt(0)
    v_readfirstlane_b32 s60, v15
    s_add_u32 s59, s59, 1
    s_nop 3
    s_cmp_ge_u32 s60, 16
    s_cbranch_scc1 K2_ODONE
    s_cmp_lt_u32 s59, 40000
    s_cbranch_scc1 K2_OPOLL
    K2_ODONE:
    s_mov_b64 exec, -1
K2_OOK:
    s_add_u32 s62, s46, s52
    buffer_load_dwordx4 v[80:83], v5, s[28:31], s62 offen sc1
    buffer_load_dwordx4 v[84:87], v6, s[28:31], s62 offen sc1
    s_add_u32 s46, s46, 4096
    s_and_b32 s46, s46, 0x7fff
    s_lshl_b32 s63, s50, 4
    s_add_u32 m0, s53, 4096
    s_add_u32 s61, s63, 7168
    buffer_load_dwordx4 v7, s[72:75], s63 offen lds
    buffer_load_dwordx4 v7, s[72:75], s61 offen offset:1024 lds
    s_add_u32 s50, s50, 4096
    s_and_b32 s50, s50, 0x7fff
    ds_read_b64_tr_b16 v[152:153], v8 offset:10240
    ds_read_b64_tr_b16 v[154:155], v8 offset:10752
    ds_read_b64_tr_b16 v[156:157], v9 offset:10240
    ds_read_b64_tr_b16 v[158:159], v9 offset:10752
s_waitcnt lgkmcnt(10)
    v_mfma_f32_32x32x16_bf16 v[192:207], v[136:139], v[120:123], v[192:207]
s_waitcnt lgkmcnt(8)
    v_mfma_f32_32x32x16_bf16 v[208:223], v[140:143], v[120:123], v[208:223]
    v_mfma_f32_32x32x16_bf16 v[224:239], v[136:139], v[124:127], v[224:239]
    v_mfma_f32_32x32x16_bf16 v[240:255], v[140:143], v[124:127], v[240:255]
    s_add_u32 s62, s46, s52
    buffer_load_dwordx4 v[88:91], v5, s[28:31], s62 offen sc1
    buffer_load_dwordx4 v[92:95], v6, s[28:31], s62 offen sc1
    s_add_u32 s46, s46, 4096
    s_and_b32 s46, s46, 0x7fff
    s_lshl_b32 s63, s50, 4
    s_add_u32 m0, s53, 6144
    s_add_u32 s61, s63, 7168
    buffer_load_dwordx4 v7, s[72:75], s63 offen lds
    buffer_load_dwordx4 v7, s[72:75], s61 offen offset:1024 lds
    s_add_u32 s50, s50, 4096
    s_and_b32 s50, s50, 0x7fff
    ds_read_b64_tr_b16 v[128:129], v8 offset:12288
    ds_read_b64_tr_b16 v[130:131], v8 offset:12800
    ds_read_b64_tr_b16 v[132:133], v9 offset:12288
    ds_read_b64_tr_b16 v[134:135], v9 offset:12800
s_waitcnt lgkmcnt(10)
    v_mfma_f32_32x32x16_bf16 v[192:207], v[144:147], v[16:19], v[192:207]
s_waitcnt lgkmcnt(8)
    v_mfma_f32_32x32x16_bf16 v[208:223], v[148:151], v[16:19], v[208:223]
    v_mfma_f32_32x32x16_bf16 v[224:239], v[144:147], v[20:23], v[224:239]
    v_mfma_f32_32x32x16_bf16 v[240:255], v[148:151], v[20:23], v[240:255]
    s_add_u32 s62, s46, s52
    buffer_load_dwordx4 v[96:99], v5, s[28:31], s62 offen sc1
    buffer_load_dwordx4 v[100:103], v6, s[28:31], s62 offen sc1
    s_add_u32 s46, s46, 4096
    s_and_b32 s46, s46, 0x7fff
    s_lshl_b32 s63, s50, 4
    s_add_u32 m0, s53, 8192
    s_add_u32 s61, s63, 7168
    buffer_load_dwordx4 v7, s[72:75], s63 offen lds
    buffer_load_dwordx4 v7, s[72:75], s61 offen offset:1024 lds
    s_add_u32 s50, s50, 4096
    s_and_b32 s50, s50, 0x7fff
    ds_read_b64_tr_b16 v[136:137], v8 offset:14336
    ds_read_b64_tr_b16 v[138:139], v8 offset:14848
    ds_read_b64_tr_b16 v[140:141], v9 offset:14336
    ds_read_b64_tr_b16 v[142:143], v9 offset:14848
s_waitcnt lgkmcnt(10)
    v_mfma_f32_32x32x16_bf16 v[192:207], v[152:155], v[24:27], v[192:207]
s_waitcnt lgkmcnt(8)
    v_mfma_f32_32x32x16_bf16 v[208:223], v[156:159], v[24:27], v[208:223]
    v_mfma_f32_32x32x16_bf16 v[224:239], v[152:155], v[28:31], v[224:239]
    v_mfma_f32_32x32x16_bf16 v[240:255], v[156:159], v[28:31], v[240:255]
    s_add_u32 s62, s46, s52
    buffer_load_dwordx4 v[104:107], v5, s[28:31], s62 offen sc1
    buffer_load_dwordx4 v[108:111], v6, s[28:31], s62 offen sc1
    s_add_u32 s46, s46, 4096
    s_and_b32 s46, s46, 0x7fff
    s_lshl_b32 s63, s50, 4
    s_add_u32 m0, s53, 10240
    s_add_u32 s61, s63, 7168
    buffer_load_dwordx4 v7, s[72:75], s63 offen lds
    buffer_load_dwordx4 v7, s[72:75], s61 offen offset:1024 lds
    s_add_u32 s50, s50, 4096
    s_and_b32 s50, s50, 0x7fff
s_waitcnt vmcnt(28)
    ds_read_b64_tr_b16 v[144:145], v8 offset:16384
    ds_read_b64_tr_b16 v[146:147], v8 offset:16896
    ds_read_b64_tr_b16 v[148:149], v9 offset:16384
    ds_read_b64_tr_b16 v[150:151], v9 offset:16896
s_waitcnt lgkmcnt(10)
    v_mfma_f32_32x32x16_bf16 v[192:207], v[128:131], v[32:35], v[192:207]
s_waitcnt lgkmcnt(8)
    v_mfma_f32_32x32x16_bf16 v[208:223], v[132:135], v[32:35], v[208:223]
    v_mfma_f32_32x32x16_bf16 v[224:239], v[128:131], v[36:39], v[224:239]
    v_mfma_f32_32x32x16_bf16 v[240:255], v[132:135], v[36:39], v[240:255]
    s_add_u32 s62, s46, s52
    buffer_load_dwordx4 v[112:115], v5, s[28:31], s62 offen sc1
    buffer_load_dwordx4 v[116:119], v6, s[28:31], s62 offen sc1
    s_add_u32 s46, s46, 4096
    s_and_b32 s46, s46, 0x7fff
    s_lshl_b32 s63, s50, 4
    s_add_u32 m0, s53, 12288
    s_add_u32 s61, s63, 7168
    buffer_load_dwordx4 v7, s[72:75], s63 offen lds
    buffer_load_dwordx4 v7, s[72:75], s61 offen offset:1024 lds
    s_add_u32 s50, s50, 4096
    s_and_b32 s50, s50, 0x7fff
s_waitcnt vmcnt(28)
    ds_read_b64_tr_b16 v[152:153], v8 offset:18432
    ds_read_b64_tr_b16 v[154:155], v8 offset:18944
    ds_read_b64_tr_b16 v[156:157], v9 offset:18432
    ds_read_b64_tr_b16 v[158:159], v9 offset:18944
s_waitcnt lgkmcnt(10)
    v_mfma_f32_32x32x16_bf16 v[192:207], v[136:139], v[40:43], v[192:207]
s_waitcnt lgkmcnt(8)
    v_mfma_f32_32x32x16_bf16 v[208:223], v[140:143], v[40:43], v[208:223]
    v_mfma_f32_32x32x16_bf16 v[224:239], v[136:139], v[44:47], v[224:239]
    v_mfma_f32_32x32x16_bf16 v[240:255], v[140:143], v[44:47], v[240:255]
    s_add_u32 s62, s46, s52
    buffer_load_dwordx4 v[120:123], v5, s[28:31], s62 offen sc1
    buffer_load_dwordx4 v[124:127], v6, s[28:31], s62 offen sc1
    s_add_u32 s46, s46, 4096
    s_and_b32 s46, s46, 0x7fff
    s_lshl_b32 s63, s50, 4
    s_add_u32 m0, s53, 14336
    s_add_u32 s61, s63, 7168
    buffer_load_dwordx4 v7, s[72:75], s63 offen lds
    buffer_load_dwordx4 v7, s[72:75], s61 offen offset:1024 lds
    s_add_u32 s50, s50, 4096
    s_and_b32 s50, s50, 0x7fff
s_waitcnt vmcnt(28)
    ds_read_b64_tr_b16 v[128:129], v8 offset:0
    ds_read_b64_tr_b16 v[130:131], v8 offset:512
    ds_read_b64_tr_b16 v[132:133], v9 offset:0
    ds_read_b64_tr_b16 v[134:135], v9 offset:512
s_waitcnt lgkmcnt(10)
    v_mfma_f32_32x32x16_bf16 v[192:207], v[144:147], v[48:51], v[192:207]
s_waitcnt lgkmcnt(8)
    v_mfma_f32_32x32x16_bf16 v[208:223], v[148:151], v[48:51], v[208:223]
    v_mfma_f32_32x32x16_bf16 v[224:239], v[144:147], v[52:55], v[224:239]
    v_mfma_f32_32x32x16_bf16 v[240:255], v[148:151], v[52:55], v[240:255]
    s_add_u32 s62, s46, s52
    buffer_load_dwordx4 v[16:19], v5, s[28:31], s62 offen sc1
    buffer_load_dwordx4 v[20:23], v6, s[28:31], s62 offen sc1
    s_add_u32 s46, s46, 4096
    s_and_b32 s46, s46, 0x7fff
    s_lshl_b32 s63, s50, 4
    s_add_u32 m0, s53, 16384
    s_add_u32 s61, s63, 7168
    buffer_load_dwordx4 v7, s[72:75], s63 offen lds
    buffer_load_dwordx4 v7, s[72:75], s61 offen offset:1024 lds
    s_add_u32 s50, s50, 4096
    s_and_b32 s50, s50, 0x7fff
s_waitcnt vmcnt(28)
    ds_read_b64_tr_b16 v[136:137], v8 offset:2048
    ds_read_b64_tr_b16 v[138:139], v8 offset:2560
    ds_read_b64_tr_b16 v[140:141], v9 offset:2048
    ds_read_b64_tr_b16 v[142:143], v9 offset:2560
s_waitcnt lgkmcnt(10)
    v_mfma_f32_32x32x16_bf16 v[192:207], v[152:155], v[56:59], v[192:207]
s_waitcnt lgkmcnt(8)
    v_mfma_f32_32x32x16_bf16 v[208:223], v[156:159], v[56:59], v[208:223]
    v_mfma_f32_32x32x16_bf16 v[224:239], v[152:155], v[60:63], v[224:239]
    v_mfma_f32_32x32x16_bf16 v[240:255], v[156:159], v[60:63], v[240:255]
    s_add_u32 s62, s46, s52
    buffer_load_dwordx4 v[24:27], v5, s[28:31], s62 offen sc1
    buffer_load_dwordx4 v[28:31], v6, s[28:31], s62 offen sc1
    s_lshl_b32 s63, s50, 4
    s_add_u32 m0, s53, 18432
    s_add_u32 s61, s63, 7168
    buffer_load_dwordx4 v7, s[72:75], s63 offen lds
    buffer_load_dwordx4 v7, s[72:75], s61 offen offset:1024 lds
s_waitcnt vmcnt(28)
    ds_read_b64_tr_b16 v[144:145], v8 offset:4096
    ds_read_b64_tr_b16 v[146:147], v8 offset:4608
    ds_read_b64_tr_b16 v[148:149], v9 offset:4096
    ds_read_b64_tr_b16 v[150:151], v9 offset:4608
s_waitcnt lgkmcnt(10)
    v_mfma_f32_32x32x16_bf16 v[192:207], v[128:131], v[64:67], v[192:207]
s_waitcnt lgkmcnt(8)
    v_mfma_f32_32x32x16_bf16 v[208:223], v[132:135], v[64:67], v[208:223]
    v_mfma_f32_32x32x16_bf16 v[224:239], v[128:131], v[68:71], v[224:239]
    v_mfma_f32_32x32x16_bf16 v[240:255], v[132:135], v[68:71], v[240:255]
s_waitcnt vmcnt(24)
    ds_read_b64_tr_b16 v[152:153], v8 offset:6144
    ds_read_b64_tr_b16 v[154:155], v8 offset:6656
    ds_read_b64_tr_b16 v[156:157], v9 offset:6144
    ds_read_b64_tr_b16 v[158:159], v9 offset:6656
s_waitcnt lgkmcnt(10)
    v_mfma_f32_32x32x16_bf16 v[192:207], v[136:139], v[72:75], v[192:207]
s_waitcnt lgkmcnt(8)
    v_mfma_f32_32x32x16_bf16 v[208:223], v[140:143], v[72:75], v[208:223]
    v_mfma_f32_32x32x16_bf16 v[224:239], v[136:139], v[76:79], v[224:239]
    v_mfma_f32_32x32x16_bf16 v[240:255], v[140:143], v[76:79], v[240:255]
    s_xor_b32 s54, s44, 1
    s_mul_i32 s54, s54, 12288
    s_add_u32 s54, s54, 81920
    v_add_u32 v10, s54, v1
s_nop 5
    ds_write_b128 v10, v[208:211] offset:0
    ds_write_b128 v10, v[212:215] offset:1024
    ds_write_b128 v10, v[216:219] offset:2048
    ds_write_b128 v10, v[220:223] offset:3072
    s_xor_b32 s54, s44, 2
    s_mul_i32 s54, s54, 12288
    s_add_u32 s54, s54, 86016
    v_add_u32 v11, s54, v1
    ds_write_b128 v11, v[224:227] offset:0
    ds_write_b128 v11, v[228:231] offset:1024
    ds_write_b128 v11, v[232:235] offset:2048
    ds_write_b128 v11, v[236:239] offset:3072
    s_xor_b32 s54, s44, 3
    s_mul_i32 s54, s54, 12288
    s_add_u32 s54, s54, 90112
    v_add_u32 v12, s54, v1
    ds_write_b128 v12, v[240:243] offset:0
    ds_write_b128 v12, v[244:247] offset:1024
    ds_write_b128 v12, v[248:251] offset:2048
    ds_write_b128 v12, v[252:255] offset:3072
s_waitcnt vmcnt(20)
    ds_read_b64_tr_b16 v[128:129], v8 offset:8192
    ds_read_b64_tr_b16 v[130:131], v8 offset:8704
    ds_read_b64_tr_b16 v[132:133], v9 offset:8192
    ds_read_b64_tr_b16 v[134:135], v9 offset:8704
s_waitcnt lgkmcnt(15)
    v_mfma_f32_32x32x16_bf16 v[176:191], v[144:147], v[80:83], 0
    v_mfma_f32_32x32x16_bf16 v[208:223], v[148:151], v[80:83], 0
    v_mfma_f32_32x32x16_bf16 v[224:239], v[144:147], v[84:87], 0
    v_mfma_f32_32x32x16_bf16 v[240:255], v[148:151], v[84:87], 0
s_waitcnt vmcnt(16)
    ds_read_b64_tr_b16 v[136:137], v8 offset:10240
    ds_read_b64_tr_b16 v[138:139], v8 offset:10752
    ds_read_b64_tr_b16 v[140:141], v9 offset:10240
    ds_read_b64_tr_b16 v[142:143], v9 offset:10752
    v_mfma_f32_32x32x16_bf16 v[176:191], v[152:155], v[88:91], v[176:191]
    v_mfma_f32_32x32x16_bf16 v[208:223], v[156:159], v[88:91], v[208:223]
    v_mfma_f32_32x32x16_bf16 v[224:239], v[152:155], v[92:95], v[224:239]
    v_mfma_f32_32x32x16_bf16 v[240:255], v[156:159], v[92:95], v[240:255]
s_waitcnt lgkmcnt(0)
    s_barrier
    s_mul_i32 s54, s44, 12288
    s_add_u32 s54, s54, 81920
    v_add_u32 v12, s54, v1
    ds_read_b128 v[168:171], v12 offset:0
    ds_read_b128 v[172:175], v12 offset:1024
s_waitcnt lgkmcnt(1)
    v_add_f32 v192, v192, v168
    v_add_f32 v193, v193, v169
    v_add_f32 v194, v194, v170
    v_add_f32 v195, v195, v171
s_waitcnt lgkmcnt(0)
    v_add_f32 v196, v196, v172
    v_add_f32 v197, v197, v173
    v_add_f32 v198, v198, v174
    v_add_f32 v199, v199, v175
s_waitcnt vmcnt(12)
    ds_read_b64_tr_b16 v[144:145], v8 offset:12288
    ds_read_b64_tr_b16 v[146:147], v8 offset:12800
    ds_read_b64_tr_b16 v[148:149], v9 offset:12288
    ds_read_b64_tr_b16 v[150:151], v9 offset:12800
    v_mfma_f32_32x32x16_bf16 v[176:191], v[128:131], v[96:99], v[176:191]
    v_mfma_f32_32x32x16_bf16 v[208:223], v[132:135], v[96:99], v[208:223]
    v_mfma_f32_32x32x16_bf16 v[224:239], v[128:131], v[100:103], v[224:239]
    v_mfma_f32_32x32x16_bf16 v[240:255], v[132:135], v[100:103], v[240:255]
    v_and_b32 v13, 31, v4
    s_lshr_b32 s54, s44, 1
    s_lshl_b32 s54, s54, 5
    s_lshl_b32 s55, s47, 6
    s_add_u32 s54, s54, s55
    v_add_u32 v13, s54, v13
    v_lshlrev_b32 v13, 10, v13
    v_lshrrev_b32 v14, 5, v4
    v_lshl_add_u32 v13, v14, 5, v13
    s_and_b32 s54, s44, 1
    s_lshl_b32 s54, s54, 6
    s_lshl_b32 s55, s48, 7
    s_add_u32 s54, s54, s55
    v_add_u32 v2, s54, v13
    buffer_load_dwordx4 v[160:163], v2, s[32:35], 0 offen
    buffer_load_dwordx4 v[164:167], v2, s[32:35], 0 offen offset:16
    ds_read_b128 v[168:171], v12 offset:2048
    ds_read_b128 v[172:175], v12 offset:3072
s_waitcnt lgkmcnt(1)
    v_add_f32 v200, v200, v168
    v_add_f32 v201, v201, v169
    v_add_f32 v202, v202, v170
    v_add_f32 v203, v203, v171
s_waitcnt lgkmcnt(0)
    v_add_f32 v204, v204, v172
    v_add_f32 v205, v205, v173
    v_add_f32 v206, v206, v174
    v_add_f32 v207, v207, v175
s_waitcnt vmcnt(10)
    ds_read_b64_tr_b16 v[152:153], v8 offset:14336
    ds_read_b64_tr_b16 v[154:155], v8 offset:14848
    ds_read_b64_tr_b16 v[156:157], v9 offset:14336
    ds_read_b64_tr_b16 v[158:159], v9 offset:14848
    v_mfma_f32_32x32x16_bf16 v[176:191], v[136:139], v[104:107], v[176:191]
    v_mfma_f32_32x32x16_bf16 v[208:223], v[140:143], v[104:107], v[208:223]
    v_mfma_f32_32x32x16_bf16 v[224:239], v[136:139], v[108:111], v[224:239]
    v_mfma_f32_32x32x16_bf16 v[240:255], v[140:143], v[108:111], v[240:255]
    ds_read_b128 v[168:171], v12 offset:4096
    ds_read_b128 v[172:175], v12 offset:5120
s_waitcnt lgkmcnt(1)
    v_add_f32 v192, v192, v168
    v_add_f32 v193, v193, v169
    v_add_f32 v194, v194, v170
    v_add_f32 v195, v195, v171
s_waitcnt lgkmcnt(0)
    v_add_f32 v196, v196, v172
    v_add_f32 v197, v197, v173
    v_add_f32 v198, v198, v174
    v_add_f32 v199, v199, v175
s_waitcnt vmcnt(6)
    ds_read_b64_tr_b16 v[128:129], v8 offset:16384
    ds_read_b64_tr_b16 v[130:131], v8 offset:16896
    ds_read_b64_tr_b16 v[132:133], v9 offset:16384
    ds_read_b64_tr_b16 v[134:135], v9 offset:16896
    v_mfma_f32_32x32x16_bf16 v[176:191], v[144:147], v[112:115], v[176:191]
    v_mfma_f32_32x32x16_bf16 v[208:223], v[148:151], v[112:115], v[208:223]
    v_mfma_f32_32x32x16_bf16 v[224:239], v[144:147], v[116:119], v[224:239]
    v_mfma_f32_32x32x16_bf16 v[240:255], v[148:151], v[116:119], v[240:255]
    ds_read_b128 v[168:171], v12 offset:6144
    ds_read_b128 v[172:175], v12 offset:7168
s_waitcnt lgkmcnt(1)
    v_add_f32 v200, v200, v168
    v_add_f32 v201, v201, v169
    v_add_f32 v202, v202, v170
    v_add_f32 v203, v203, v171
s_waitcnt lgkmcnt(0)
    v_add_f32 v204, v204, v172
    v_add_f32 v205, v205, v173
    v_add_f32 v206, v206, v174
    v_add_f32 v207, v207, v175
s_waitcnt vmcnt(2)
    ds_read_b64_tr_b16 v[136:137], v8 offset:18432
    ds_read_b64_tr_b16 v[138:139], v8 offset:18944
    ds_read_b64_tr_b16 v[140:141], v9 offset:18432
    ds_read_b64_tr_b16 v[142:143], v9 offset:18944
    v_mfma_f32_32x32x16_bf16 v[176:191], v[152:155], v[120:123], v[176:191]
    v_mfma_f32_32x32x16_bf16 v[208:223], v[156:159], v[120:123], v[208:223]
    v_mfma_f32_32x32x16_bf16 v[224:239], v[152:155], v[124:127], v[224:239]
    v_mfma_f32_32x32x16_bf16 v[240:255], v[156:159], v[124:127], v[240:255]
    ds_read_b128 v[168:171], v12 offset:8192
    ds_read_b128 v[172:175], v12 offset:9216
s_waitcnt lgkmcnt(1)
    v_add_f32 v192, v192, v168
    v_add_f32 v193, v193, v169
    v_add_f32 v194, v194, v170
    v_add_f32 v195, v195, v171
s_waitcnt lgkmcnt(0)
    v_add_f32 v196, v196, v172
    v_add_f32 v197, v197, v173
    v_add_f32 v198, v198, v174
    v_add_f32 v199, v199, v175
    v_mfma_f32_32x32x16_bf16 v[176:191], v[128:131], v[16:19], v[176:191]
    v_mfma_f32_32x32x16_bf16 v[208:223], v[132:135], v[16:19], v[208:223]
    v_mfma_f32_32x32x16_bf16 v[224:239], v[128:131], v[20:23], v[224:239]
    v_mfma_f32_32x32x16_bf16 v[240:255], v[132:135], v[20:23], v[240:255]
    ds_read_b128 v[168:171], v12 offset:10240
    ds_read_b128 v[172:175], v12 offset:11264
s_waitcnt lgkmcnt(1)
    v_add_f32 v200, v200, v168
    v_add_f32 v201, v201, v169
    v_add_f32 v202, v202, v170
    v_add_f32 v203, v203, v171
s_waitcnt lgkmcnt(0)
    v_add_f32 v204, v204, v172
    v_add_f32 v205, v205, v173
    v_add_f32 v206, v206, v174
    v_add_f32 v207, v207, v175
    v_mfma_f32_32x32x16_bf16 v[176:191], v[136:139], v[24:27], v[176:191]
    v_mfma_f32_32x32x16_bf16 v[208:223], v[140:143], v[24:27], v[208:223]
    v_mfma_f32_32x32x16_bf16 v[224:239], v[136:139], v[28:31], v[224:239]
    v_mfma_f32_32x32x16_bf16 v[240:255], v[140:143], v[28:31], v[240:255]
    s_add_u32 s54, s53, 0
    v_add_u32 v10, s54, v1
s_nop 7
    ds_write_b128 v10, v[208:211] offset:0
    ds_write_b128 v10, v[212:215] offset:1024
    ds_write_b128 v10, v[216:219] offset:2048
    ds_write_b128 v10, v[220:223] offset:3072
    s_add_u32 s54, s53, 4096
    v_add_u32 v11, s54, v1
    ds_write_b128 v11, v[224:227] offset:0
    ds_write_b128 v11, v[228:231] offset:1024
    ds_write_b128 v11, v[232:235] offset:2048
    ds_write_b128 v11, v[236:239] offset:3072
    s_add_u32 s54, s53, 8192
    v_add_u32 v12, s54, v1
    ds_write_b128 v12, v[240:243] offset:0
    ds_write_b128 v12, v[244:247] offset:1024
    ds_write_b128 v12, v[248:251] offset:2048
    ds_write_b128 v12, v[252:255] offset:3072
s_waitcnt lgkmcnt(0)
    s_barrier
    s_xor_b32 s54, s44, 1
    s_mul_i32 s54, s54, 20480
    s_add_u32 s54, s54, 0
    v_add_u32 v10, s54, v1
    ds_read_b128 v[16:19], v10 offset:0
    ds_read_b128 v[20:23], v10 offset:1024
    ds_read_b128 v[24:27], v10 offset:2048
    ds_read_b128 v[28:31], v10 offset:3072
    s_xor_b32 s54, s44, 2
    s_mul_i32 s54, s54, 20480
    s_add_u32 s54, s54, 4096
    v_add_u32 v11, s54, v1
    ds_read_b128 v[32:35], v11 offset:0
    ds_read_b128 v[36:39], v11 offset:1024
    ds_read_b128 v[40:43], v11 offset:2048
    ds_read_b128 v[44:47], v11 offset:3072
    s_xor_b32 s54, s44, 3
    s_mul_i32 s54, s54, 20480
    s_add_u32 s54, s54, 8192
    v_add_u32 v12, s54, v1
    ds_read_b128 v[48:51], v12 offset:0
    ds_read_b128 v[52:55], v12 offset:1024
    ds_read_b128 v[56:59], v12 offset:2048
    ds_read_b128 v[60:63], v12 offset:3072
s_waitcnt vmcnt(1)
    v_lshlrev_b32 v80, 16, v160
    v_and_b32 v81, 0xffff0000, v160
    v_lshlrev_b32 v82, 16, v161
    v_and_b32 v83, 0xffff0000, v161
    v_lshlrev_b32 v84, 16, v162
    v_and_b32 v85, 0xffff0000, v162
    v_lshlrev_b32 v86, 16, v163
    v_and_b32 v87, 0xffff0000, v163
s_waitcnt vmcnt(0)
    v_lshlrev_b32 v88, 16, v164
    v_and_b32 v89, 0xffff0000, v164
    v_lshlrev_b32 v90, 16, v165
    v_and_b32 v91, 0xffff0000, v165
    v_lshlrev_b32 v92, 16, v166
    v_and_b32 v93, 0xffff0000, v166
    v_lshlrev_b32 v94, 16, v167
    v_and_b32 v95, 0xffff0000, v167
    v_mul_f32 v64, 0xbfb8aa3b, v192
    v_mul_f32 v65, 0xbfb8aa3b, v193
    v_mul_f32 v66, 0xbfb8aa3b, v194
    v_mul_f32 v67, 0xbfb8aa3b, v195
    v_mul_f32 v68, 0xbfb8aa3b, v196
    v_mul_f32 v69, 0xbfb8aa3b, v197
    v_mul_f32 v70, 0xbfb8aa3b, v198
    v_mul_f32 v71, 0xbfb8aa3b, v199
    v_mul_f32 v72, 0xbfb8aa3b, v200
    v_mul_f32 v73, 0xbfb8aa3b, v201
    v_mul_f32 v74, 0xbfb8aa3b, v202
    v_mul_f32 v75, 0xbfb8aa3b, v203
    v_mul_f32 v76, 0xbfb8aa3b, v204
    v_mul_f32 v77, 0xbfb8aa3b, v205
    v_mul_f32 v78, 0xbfb8aa3b, v206
    v_mul_f32 v79, 0xbfb8aa3b, v207
    v_exp_f32 v64, v64
    v_exp_f32 v65, v65
    v_exp_f32 v66, v66
    v_exp_f32 v67, v67
    v_exp_f32 v68, v68
    v_exp_f32 v69, v69
    v_exp_f32 v70, v70
    v_exp_f32 v71, v71
    v_exp_f32 v72, v72
    v_exp_f32 v73, v73
    v_exp_f32 v74, v74
    v_exp_f32 v75, v75
    v_exp_f32 v76, v76
    v_exp_f32 v77, v77
    v_exp_f32 v78, v78
    v_exp_f32 v79, v79
    v_add_f32 v64, 1.0, v64
    v_add_f32 v65, 1.0, v65
    v_add_f32 v66, 1.0, v66
    v_add_f32 v67, 1.0, v67
    v_add_f32 v68, 1.0, v68
    v_add_f32 v69, 1.0, v69
    v_add_f32 v70, 1.0, v70
    v_add_f32 v71, 1.0, v71
    v_add_f32 v72, 1.0, v72
    v_add_f32 v73, 1.0, v73
    v_add_f32 v74, 1.0, v74
    v_add_f32 v75, 1.0, v75
    v_add_f32 v76, 1.0, v76
    v_add_f32 v77, 1.0, v77
    v_add_f32 v78, 1.0, v78
    v_add_f32 v79, 1.0, v79
    v_rcp_f32 v64, v64
    v_rcp_f32 v65, v65
    v_rcp_f32 v66, v66
    v_rcp_f32 v67, v67
    v_rcp_f32 v68, v68
    v_rcp_f32 v69, v69
    v_rcp_f32 v70, v70
    v_rcp_f32 v71, v71
    v_rcp_f32 v72, v72
    v_rcp_f32 v73, v73
    v_rcp_f32 v74, v74
    v_rcp_f32 v75, v75
    v_rcp_f32 v76, v76
    v_rcp_f32 v77, v77
    v_rcp_f32 v78, v78
    v_rcp_f32 v79, v79
    v_mul_f32 v64, v64, v192
    v_mul_f32 v65, v65, v193
    v_mul_f32 v66, v66, v194
    v_mul_f32 v67, v67, v195
    v_mul_f32 v68, v68, v196
    v_mul_f32 v69, v69, v197
    v_mul_f32 v70, v70, v198
    v_mul_f32 v71, v71, v199
    v_mul_f32 v72, v72, v200
    v_mul_f32 v73, v73, v201
    v_mul_f32 v74, v74, v202
    v_mul_f32 v75, v75, v203
    v_mul_f32 v76, v76, v204
    v_mul_f32 v77, v77, v205
    v_mul_f32 v78, v78, v206
    v_mul_f32 v79, v79, v207
s_waitcnt lgkmcnt(11)
    v_add_f32 v176, v176, v16
    v_add_f32 v177, v177, v17
    v_add_f32 v178, v178, v18
    v_add_f32 v179, v179, v19
s_waitcnt lgkmcnt(10)
    v_add_f32 v180, v180, v20
    v_add_f32 v181, v181, v21
    v_add_f32 v182, v182, v22
    v_add_f32 v183, v183, v23
s_waitcnt lgkmcnt(9)
    v_add_f32 v184, v184, v24
    v_add_f32 v185, v185, v25
    v_add_f32 v186, v186, v26
    v_add_f32 v187, v187, v27
s_waitcnt lgkmcnt(8)
    v_add_f32 v188, v188, v28
    v_add_f32 v189, v189, v29
    v_add_f32 v190, v190, v30
    v_add_f32 v191, v191, v31
s_waitcnt lgkmcnt(7)
    v_add_f32 v176, v176, v32
    v_add_f32 v177, v177, v33
    v_add_f32 v178, v178, v34
    v_add_f32 v179, v179, v35
s_waitcnt lgkmcnt(6)
    v_add_f32 v180, v180, v36
    v_add_f32 v181, v181, v37
    v_add_f32 v182, v182, v38
    v_add_f32 v183, v183, v39
s_waitcnt lgkmcnt(5)
    v_add_f32 v184, v184, v40
    v_add_f32 v185, v185, v41
    v_add_f32 v186, v186, v42
    v_add_f32 v187, v187, v43
s_waitcnt lgkmcnt(4)
    v_add_f32 v188, v188, v44
    v_add_f32 v189, v189, v45
    v_add_f32 v190, v190, v46
    v_add_f32 v191, v191, v47
s_waitcnt lgkmcnt(3)
    v_add_f32 v176, v176, v48
    v_add_f32 v177, v177, v49
    v_add_f32 v178, v178, v50
    v_add_f32 v179, v179, v51
s_waitcnt lgkmcnt(2)
    v_add_f32 v180, v180, v52
    v_add_f32 v181, v181, v53
    v_add_f32 v182, v182, v54
    v_add_f32 v183, v183, v55
s_waitcnt lgkmcnt(1)
    v_add_f32 v184, v184, v56
    v_add_f32 v185, v185, v57
    v_add_f32 v186, v186, v58
    v_add_f32 v187, v187, v59
s_waitcnt lgkmcnt(0)
    v_add_f32 v188, v188, v60
    v_add_f32 v189, v189, v61
    v_add_f32 v190, v190, v62
    v_add_f32 v191, v191, v63
    v_fma_f32 v80, v176, v64, v80
    v_fma_f32 v81, v177, v65, v81
    v_fma_f32 v82, v178, v66, v82
    v_fma_f32 v83, v179, v67, v83
    v_fma_f32 v84, v180, v68, v84
    v_fma_f32 v85, v181, v69, v85
    v_fma_f32 v86, v182, v70, v86
    v_fma_f32 v87, v183, v71, v87
    v_fma_f32 v88, v184, v72, v88
    v_fma_f32 v89, v185, v73, v89
    v_fma_f32 v90, v186, v74, v90
    v_fma_f32 v91, v187, v75, v91
    v_fma_f32 v92, v188, v76, v92
    v_fma_f32 v93, v189, v77, v93
    v_fma_f32 v94, v190, v78, v94
    v_fma_f32 v95, v191, v79, v95
    v_cvt_pk_bf16_f32 v96, v80, v81
    v_cvt_pk_bf16_f32 v97, v82, v83
    v_cvt_pk_bf16_f32 v98, v84, v85
    v_cvt_pk_bf16_f32 v99, v86, v87
    v_cvt_pk_bf16_f32 v100, v88, v89
    v_cvt_pk_bf16_f32 v101, v90, v91
    v_cvt_pk_bf16_f32 v102, v92, v93
    v_cvt_pk_bf16_f32 v103, v94, v95
    buffer_store_dwordx4 v[96:99], v2, s[36:39], 0 offen
    buffer_store_dwordx4 v[100:103], v2, s[36:39], 0 offen offset:16
K2_END:
    s_endpgm
.section .rodata,"a"
.p2align 6
.amdhsa_kernel recurrent_scan__linear_kernel_hedgehog__geglu_ffn__prompt_kernel
  .amdhsa_next_free_vgpr 256
  .amdhsa_next_free_sgpr 102
  .amdhsa_accum_offset 256
  .amdhsa_group_segment_fixed_size 0
  .amdhsa_kernarg_size 88
  .amdhsa_user_sgpr_count 2
  .amdhsa_user_sgpr_kernarg_segment_ptr 1
  .amdhsa_system_sgpr_workgroup_id_x 1
.end_amdhsa_kernel
```
